```python
import torch

def _softmax(x, axis=-1):
    return torch.softmax(x, dim=axis)
def _gelu(x):
    return torch.nn.functional.gelu(x, approximate="tanh")
def _silu(x):
    return torch.nn.functional.silu(x)
def _sigmoid(x):
    return torch.sigmoid(x)
def _layernorm(x, axis=-1, eps=1e-5):
    m = x.mean(dim=axis, keepdim=True)
    v = x.var(dim=axis, keepdim=True, unbiased=False)
    return (x - m) / torch.sqrt(v + eps)
def _scatter_add(tgt, idx, src, axis=0):
    return tgt.clone().index_add_(axis, idx, src)
def _segment_sum(src, seg, n):
    out = torch.zeros((n,) + src.shape[1:], dtype=src.dtype)
    return out.index_add_(0, seg, src)
def _pad(x, pw):
    flat = tuple(v for pair in reversed(pw) for v in pair)
    return torch.nn.functional.pad(x, flat)

kernel_name = 'standalone__paged_block_table_kv_pagedattention__sampling'

def setup_inputs():

    _w = (lambda a: (lambda t: t.to(torch.bfloat16) if t.is_floating_point() else t)(torch.as_tensor(a)))
    B, Hq, Hkv, Sq, Skv, D = 16, 32, 16, 16, 4096, 128
    bs = 16
    nbps = max(1, Skv // bs)
    num_phys = B * nbps + 4
    bt = torch.randperm(num_phys)[: B * nbps].reshape(B, nbps).to(torch.int64)
    cl = (nbps * bs - (torch.arange(1, B + 1, dtype=torch.int64) * 2654435761) % max(1, nbps * bs // 2)).to(torch.int64)
    return {
        "q": _w((lambda *s: torch.randn(*s, dtype=torch.bfloat16) * 0.8)(B, Hq, Sq, D)),
        "k_cache": _w((lambda *s: torch.randn(*s, dtype=torch.bfloat16) * 0.8)(num_phys, bs, Hkv, D)),
        "v_cache": _w((lambda *s: torch.randn(*s, dtype=torch.bfloat16) * 0.05)(num_phys, bs, Hkv, D)),
        "block_table": _w(bt),
        "context_lens": _w(cl),
    }

def reference(q, k_cache, v_cache, block_table, context_lens):
    B, Hq, Sq, D = q.shape
    bs = k_cache.shape[1]
    Hkv = k_cache.shape[2]
    nbps = block_table.shape[1]
    Skv = nbps * bs
    bt = block_table.reshape(-1)
    k = (lambda x, *d: x.permute(*d))(k_cache[bt].reshape(B, Skv, Hkv, D), 0, 2, 1, 3)
    v = (lambda x, *d: x.permute(*d))(v_cache[bt].reshape(B, Skv, Hkv, D), 0, 2, 1, 3)
    g = Hq // Hkv
    qg = q.reshape(B, Hkv, g, Sq, D)
    scores = torch.einsum("bhgqd,bhkd->bhgqk", qg, k) * (D ** -0.5)
    pos = torch.arange(Skv)
    msk = pos[None, :] < context_lens[:, None]
    scores = torch.where(msk[:, None, None, None, :], scores, -1e9)
    p = _softmax(scores, axis=-1)
    out = torch.einsum("bhgqk,bhkd->bhgqd", p, v)
    return out.reshape(B, Hq, Sq, D)
```

```asm
; @launch grid=(256,1,1) block=(256,1,1) lds=163840
.amdgcn_target "amdgcn-amd-amdhsa--gfx950"
.text
.globl standalone__paged_block_table_kv_pagedattention__sampling_kernel
.p2align 8
.type standalone__paged_block_table_kv_pagedattention__sampling_kernel,@function
standalone__paged_block_table_kv_pagedattention__sampling_kernel:
    s_cmp_ge_u32 s2, 256
    s_cbranch_scc1 L_exit
    s_load_dwordx16 s[36:51], s[0:1], 0
    v_lshrrev_b32 v26, 6, v0
    v_and_b32 v1, 63, v0
    v_readfirstlane_b32 s52, v26
    s_lshr_b32 s53, s2, 4
    s_and_b32 s54, s2, 15
    s_lshl_b32 s55, s54, 4
    s_add_u32 s55, s55, s53
    s_mov_b32 s81, 0x3e0293ee
    v_and_b32 v128, 15, v1
    v_lshrrev_b32 v129, 4, v1
    v_lshrrev_b32 v130, 5, v1
    v_and_b32 v131, 31, v1
    v_lshrrev_b32 v132, 2, v128
    v_and_b32 v133, 3, v1
    v_lshlrev_b32 v29, 2, v129
    v_xor_b32 v30, v128, v29
    v_add_u32 v26, 0, v129
    v_xor_b32 v27, v128, v26
    v_lshlrev_b32 v28, 12, v26
    v_lshl_add_u32 v14, v27, 4, v28
    v_lshl_add_u32 v18, v30, 4, v28
    v_add_u32 v26, 4, v129
    v_xor_b32 v27, v128, v26
    v_lshlrev_b32 v28, 12, v26
    v_subrev_u32 v28, 1024, v28
    v_lshl_add_u32 v15, v27, 4, v28
    v_lshl_add_u32 v19, v30, 4, v28
    v_add_u32 v26, 8, v129
    v_xor_b32 v27, v128, v26
    v_lshlrev_b32 v28, 12, v26
    v_subrev_u32 v28, 2048, v28
    v_lshl_add_u32 v16, v27, 4, v28
    v_lshl_add_u32 v20, v30, 4, v28
    v_add_u32 v26, 12, v129
    v_xor_b32 v27, v128, v26
    v_lshlrev_b32 v28, 12, v26
    v_subrev_u32 v28, 3072, v28
    v_lshl_add_u32 v17, v27, 4, v28
    v_lshl_add_u32 v21, v30, 4, v28
    v_lshlrev_b32 v26, 8, v131
    v_lshl_add_u32 v22, v130, 4, v26
    v_lshl_add_u32 v248, v130, 3, v26
    v_lshlrev_b32 v31, 2, v128
    s_lshl_b32 s87, s52, 3
    v_add_u32 v26, s87, v129
    v_and_b32 v27, 15, v26
    v_xor_b32 v27, v27, v128
    v_lshlrev_b32 v26, 8, v26
    v_lshl_add_u32 v134, v27, 4, v26
    v_add_u32 v26, s87, v129
    v_add_u32 v26, 4, v26
    v_and_b32 v27, 15, v26
    v_xor_b32 v27, v27, v128
    v_lshlrev_b32 v26, 8, v26
    v_lshl_add_u32 v135, v27, 4, v26
    v_subrev_u32 v135, 1024, v135
    s_lshl_b32 s89, s52, 11
    s_add_u32 m0, s89, 131072
    s_lshl_b32 s80, s52, 15
    s_lshl_b32 s63, s53, 10
    s_lshl_b32 s87, s52, 3
    s_add_u32 s87, s87, s63
    s_lshl_b32 s64, s53, 17
    s_lshl_b32 s88, s54, 13
    s_add_u32 s64, s64, s88
    s_lshl_b32 s62, s54, 8
    s_mov_b32 s14, 2097152
    s_mov_b32 s15, 0x20000
    s_mov_b32 s6, 268697600
    s_mov_b32 s7, 0x20000
    s_mov_b32 s10, 268697600
    s_mov_b32 s11, 0x20000
    s_mov_b32 s18, 16384
    s_mov_b32 s19, 0x20000
    s_mov_b32 s22, 64
    s_mov_b32 s23, 0x20000
    s_mov_b32 s26, 2097152
    s_mov_b32 s27, 0x20000
    s_mov_b32 s30, 256
    s_mov_b32 s31, 0x20000
    s_mov_b32 s34, 1074790400
    s_mov_b32 s35, 0x20000
    s_waitcnt lgkmcnt(0)
    s_mov_b32 s16, s42
    s_and_b32 s17, s43, 0xffff
    s_buffer_load_dwordx2 s[68:69], s[16:19], s87
    s_buffer_load_dwordx2 s[90:91], s[16:19], s87 offset:32
    s_mov_b32 s12, s36
    s_and_b32 s13, s37, 0xffff
    buffer_load_dwordx4 v134, s[12:15], s64 offen lds
    buffer_load_dwordx4 v135, s[12:15], s64 offen offset:1024 lds
    s_mov_b32 s20, s44
    s_and_b32 s21, s45, 0xffff
    buffer_load_dword v57, v31, s[20:23], 0 offen
    s_mov_b32 s4, s38
    s_and_b32 s5, s39, 0xffff
    s_mov_b32 s8, s40
    s_and_b32 s9, s41, 0xffff
    s_mov_b32 s24, s46
    s_and_b32 s25, s47, 0xffff
    s_mov_b32 s28, s48
    s_and_b32 s29, s49, 0xffff
    s_mov_b32 s32, s50
    s_and_b32 s33, s51, 0xffff
    v_lshlrev_b32 v26, 8, v131
    v_add_u32 v26, s80, v26
    v_or_b32 v27, 0, v130
    v_xor_b32 v27, v27, v128
    v_lshl_add_u32 v2, v27, 4, v26
    v_or_b32 v27, 2, v130
    v_xor_b32 v27, v27, v128
    v_lshl_add_u32 v3, v27, 4, v26
    v_or_b32 v27, 4, v130
    v_xor_b32 v27, v27, v128
    v_lshl_add_u32 v4, v27, 4, v26
    v_or_b32 v27, 6, v130
    v_xor_b32 v27, v27, v128
    v_lshl_add_u32 v5, v27, 4, v26
    v_or_b32 v27, 8, v130
    v_xor_b32 v27, v27, v128
    v_lshl_add_u32 v6, v27, 4, v26
    v_or_b32 v27, 10, v130
    v_xor_b32 v27, v27, v128
    v_lshl_add_u32 v7, v27, 4, v26
    v_or_b32 v27, 12, v130
    v_xor_b32 v27, v27, v128
    v_lshl_add_u32 v8, v27, 4, v26
    v_or_b32 v27, 14, v130
    v_xor_b32 v27, v27, v128
    v_lshl_add_u32 v9, v27, 4, v26
    v_lshl_add_u32 v26, v130, 2, v132
    v_lshlrev_b32 v26, 8, v26
    v_add_u32 v26, s80, v26
    v_add_u32 v26, 8192, v26
    v_and_b32 v27, 1, v129
    v_lshl_add_u32 v26, v27, 5, v26
    v_lshl_add_u32 v26, v133, 3, v26
    s_add_u32 s87, s52, 0
    s_and_b32 s87, s87, 3
    v_xor_b32 v27, s87, v132
    v_lshl_add_u32 v10, v27, 6, v26
    s_add_u32 s87, s52, 1
    s_and_b32 s87, s87, 3
    v_xor_b32 v27, s87, v132
    v_lshl_add_u32 v11, v27, 6, v26
    s_add_u32 s87, s52, 2
    s_and_b32 s87, s87, 3
    v_xor_b32 v27, s87, v132
    v_lshl_add_u32 v12, v27, 6, v26
    s_add_u32 s87, s52, 3
    s_and_b32 s87, s87, 3
    v_xor_b32 v27, s87, v132
    v_lshl_add_u32 v13, v27, 6, v26
    v_lshlrev_b32 v58, 2, v130
    v_lshlrev_b32 v60, 4, v1
    v_lshlrev_b32 v59, 3, v131
    v_lshlrev_b32 v62, 2, v1
    v_lshlrev_b32 v249, 2, v131
    v_mov_b32 v63, 147712
    s_waitcnt lgkmcnt(0)
    s_lshl_b32 s70, s68, 16
    s_lshl_b32 s71, s69, 16
    s_add_u32 s70, s70, s62
    s_add_u32 s71, s71, s62
    s_add_u32 m0, s80, 0
    s_nop 0
    buffer_load_dwordx4 v14, s[4:7], s70 offen nt lds
    buffer_load_dwordx4 v15, s[4:7], s70 offen offset:1024 nt lds
    buffer_load_dwordx4 v16, s[4:7], s70 offen offset:2048 nt lds
    buffer_load_dwordx4 v17, s[4:7], s70 offen offset:3072 nt lds
    s_add_u32 m0, s80, 4096
    s_nop 0
    buffer_load_dwordx4 v14, s[4:7], s71 offen nt lds
    buffer_load_dwordx4 v15, s[4:7], s71 offen offset:1024 nt lds
    buffer_load_dwordx4 v16, s[4:7], s71 offen offset:2048 nt lds
    buffer_load_dwordx4 v17, s[4:7], s71 offen offset:3072 nt lds
    s_add_u32 m0, s80, 8192
    s_nop 0
    buffer_load_dwordx4 v18, s[8:11], s70 offen nt lds
    buffer_load_dwordx4 v19, s[8:11], s70 offen offset:1024 nt lds
    buffer_load_dwordx4 v20, s[8:11], s70 offen offset:2048 nt lds
    buffer_load_dwordx4 v21, s[8:11], s70 offen offset:3072 nt lds
    s_add_u32 m0, s80, 12288
    s_nop 0
    buffer_load_dwordx4 v18, s[8:11], s71 offen nt lds
    buffer_load_dwordx4 v19, s[8:11], s71 offen offset:1024 nt lds
    buffer_load_dwordx4 v20, s[8:11], s71 offen offset:2048 nt lds
    buffer_load_dwordx4 v21, s[8:11], s71 offen offset:3072 nt lds
    s_mov_b32 s68, s90
    s_mov_b32 s69, s91
    s_lshl_b32 s70, s68, 16
    s_lshl_b32 s71, s69, 16
    s_add_u32 s70, s70, s62
    s_add_u32 s71, s71, s62
    v_mov_b32 v180, 0
    v_mov_b32 v181, 0
    v_mov_b32 v182, 0
    v_mov_b32 v183, 0
    ds_write_b128 v63, v[180:183]
    ds_write_b64 v63, v[180:181] offset:32
    v_mov_b32 v26, 8
    ds_write_b32 v63, v26 offset:40
    v_mov_b32 v61, 0
    s_mov_b32 exec_lo, 0xffff
    s_mov_b32 exec_hi, 0x0
    v_mov_b32 v152, 0x3dab851f
    v_mov_b32 v156, 0x407851ec
    v_mov_b32 v160, 64
    v_mov_b32 v48, 0x3c800000
    v_mov_b32 v196, 65602
    v_mov_b32 v200, 64
    v_mov_b32 v153, 0x3dab851f
    v_mov_b32 v157, 0x407851ec
    v_mov_b32 v161, 64
    v_mov_b32 v49, 0x3c800000
    v_mov_b32 v197, 65602
    v_mov_b32 v201, 64
    v_mov_b32 v154, 0x3dab851f
    v_mov_b32 v158, 0x407851ec
    v_mov_b32 v162, 64
    v_mov_b32 v50, 0x3c800000
    v_mov_b32 v198, 65602
    v_mov_b32 v202, 64
    v_mov_b32 v155, 0x3dab851f
    v_mov_b32 v159, 0x407851ec
    v_mov_b32 v163, 64
    v_mov_b32 v51, 0x3c800000
    v_mov_b32 v199, 65602
    v_mov_b32 v203, 64
    s_mov_b32 exec_lo, 0xffff0000
    s_mov_b32 exec_hi, 0x0
    v_mov_b32 v152, 0x3d79999a
    v_mov_b32 v156, 0x00000000
    v_mov_b32 v160, 72
    v_mov_b32 v48, 0x3c638e39
    v_mov_b32 v196, 65616
    v_mov_b32 v200, 66
    v_mov_b32 v153, 0x3d79999a
    v_mov_b32 v157, 0x00000000
    v_mov_b32 v161, 72
    v_mov_b32 v49, 0x3c638e39
    v_mov_b32 v197, 65616
    v_mov_b32 v201, 66
    v_mov_b32 v154, 0x3d79999a
    v_mov_b32 v158, 0x00000000
    v_mov_b32 v162, 72
    v_mov_b32 v50, 0x3c638e39
    v_mov_b32 v198, 65616
    v_mov_b32 v202, 66
    v_mov_b32 v155, 0x3d79999a
    v_mov_b32 v159, 0x00000000
    v_mov_b32 v163, 72
    v_mov_b32 v51, 0x3c638e39
    v_mov_b32 v199, 65616
    v_mov_b32 v203, 66
    s_mov_b32 exec_lo, 0x0
    s_mov_b32 exec_hi, 0xffff
    v_mov_b32 v152, 0x3dab851f
    v_mov_b32 v156, 0x407851ec
    v_mov_b32 v160, 64
    v_mov_b32 v48, 0x3c800000
    v_mov_b32 v196, 65602
    v_mov_b32 v200, 64
    v_mov_b32 v153, 0x3dab851f
    v_mov_b32 v157, 0x407851ec
    v_mov_b32 v161, 64
    v_mov_b32 v49, 0x3c800000
    v_mov_b32 v197, 65602
    v_mov_b32 v201, 64
    v_mov_b32 v154, 0x3dab851f
    v_mov_b32 v158, 0x407851ec
    v_mov_b32 v162, 64
    v_mov_b32 v50, 0x3c800000
    v_mov_b32 v198, 65602
    v_mov_b32 v202, 64
    v_mov_b32 v155, 0x3dab851f
    v_mov_b32 v159, 0x407851ec
    v_mov_b32 v163, 64
    v_mov_b32 v51, 0x3c800000
    v_mov_b32 v199, 65602
    v_mov_b32 v203, 64
    s_mov_b32 exec_lo, 0x0
    s_mov_b32 exec_hi, 0xffff0000
    v_mov_b32 v152, 0x3dab851f
    v_mov_b32 v156, 0x407851ec
    v_mov_b32 v160, 64
    v_mov_b32 v48, 0x3c800000
    v_mov_b32 v196, 65602
    v_mov_b32 v200, 64
    v_mov_b32 v153, 0x3dab851f
    v_mov_b32 v157, 0x407851ec
    v_mov_b32 v161, 64
    v_mov_b32 v49, 0x3c800000
    v_mov_b32 v197, 65602
    v_mov_b32 v201, 64
    v_mov_b32 v154, 0x3dab851f
    v_mov_b32 v158, 0x407851ec
    v_mov_b32 v162, 64
    v_mov_b32 v50, 0x3c800000
    v_mov_b32 v198, 65602
    v_mov_b32 v202, 64
    v_mov_b32 v155, 0x3d933333
    v_mov_b32 v159, 0x00000000
    v_mov_b32 v163, 64
    v_mov_b32 v51, 0x3c800000
    v_mov_b32 v199, 65602
    v_mov_b32 v203, 66
    s_mov_b64 exec, -1
    s_sub_u32 s87, 131072, s80
    v_add_u32 v144, s87, v2
    v_add_u32 v145, s87, v3
    v_add_u32 v146, s87, v4
    v_add_u32 v147, s87, v5
    v_add_u32 v148, s87, v6
    v_add_u32 v149, s87, v7
    v_add_u32 v150, s87, v8
    v_add_u32 v151, s87, v9
    s_waitcnt vmcnt(16) lgkmcnt(0)
    s_barrier
    ds_read_b128 v[216:219], v144
    ds_read_b128 v[220:223], v145
    ds_read_b128 v[224:227], v146
    ds_read_b128 v[228:231], v147
    ds_read_b128 v[232:235], v148
    ds_read_b128 v[236:239], v149
    ds_read_b128 v[240:243], v150
    ds_read_b128 v[244:247], v151
    v_min_i32 v57, 0x1000, v57
    v_add_u32 v56, 31, v57
    v_ashrrev_i32 v56, 5, v56
    v_cmp_lt_i32 vcc, 0, v57
    v_mov_b32 v26, 0x80
    v_max_i32 v57, 0, v57
    v_cndmask_b32 v56, v26, v56, vcc
    v_mov_b32 v27, v56
    s_nop 1
    v_add_u32_dpp v27, v27, v27 row_shr:1 row_mask:0xf bank_mask:0xf bound_ctrl:0
    s_nop 1
    v_add_u32_dpp v27, v27, v27 row_shr:2 row_mask:0xf bank_mask:0xf bound_ctrl:0
    s_nop 1
    v_add_u32_dpp v27, v27, v27 row_shr:4 row_mask:0xf bank_mask:0xf bound_ctrl:0
    s_nop 1
    v_add_u32_dpp v27, v27, v27 row_shr:8 row_mask:0xf bank_mask:0xf bound_ctrl:0
    s_nop 1
    v_readlane_b32 s87, v27, 15
    v_readlane_b32 s56, v56, s53
    v_readlane_b32 s58, v57, s53
    v_cvt_f32_u32 v28, s87
    v_mov_b32 v192, v28
    v_mov_b32 v193, 0
    v_mul_f32 v29, 0x3f051eb8, v28
    v_cvt_u32_f32 v29, v29
    v_max_u32 v29, 64, v29
    v_mov_b32 v30, 192
    v_fma_f32 v26, v28, v152, 0.5
    v_cvt_u32_f32 v26, v26
    v_max_u32 v26, 8, v26
    v_sub_u32 v26, v56, v26
    v_cmp_le_i32 vcc, 2, v26
    v_mul_f32 v27, v28, v156
    v_cvt_u32_f32 v27, v27
    v_cndmask_b32 v164, 0, v26, vcc
    v_mad_u32_u24 v26, v164, v160, v30
    v_cndmask_b32 v168, 0, v26, vcc
    v_sub_u32 v44, v56, v164
    v_mul_u32_u24 v26, v56, v160
    v_sub_u32 v26, v27, v26
    v_cmp_ge_i32 vcc, v26, v29
    v_mov_b32 v176, v168
    v_lshrrev_b32 v27, 1, v164
    v_cndmask_b32 v172, 0, v26, vcc
    v_cmp_eq_u32 vcc, 0, v164
    v_min_u32 v27, 16, v27
    v_sub_u32 v184, v164, v27
    v_cndmask_b32 v172, 0, v172, vcc
    v_mov_b32 v180, v172
    v_add_u32 v27, -1, v164
    v_ashrrev_i32 v27, 1, v27
    v_min_i32 v188, 16, v27
    v_fma_f32 v26, v28, v153, 0.5
    v_cvt_u32_f32 v26, v26
    v_max_u32 v26, 8, v26
    v_sub_u32 v26, v56, v26
    v_cmp_le_i32 vcc, 2, v26
    v_mul_f32 v27, v28, v157
    v_cvt_u32_f32 v27, v27
    v_cndmask_b32 v165, 0, v26, vcc
    v_mad_u32_u24 v26, v165, v161, v30
    v_cndmask_b32 v169, 0, v26, vcc
    v_sub_u32 v45, v56, v165
    v_mul_u32_u24 v26, v56, v161
    v_sub_u32 v26, v27, v26
    v_cmp_ge_i32 vcc, v26, v29
    v_mov_b32 v177, v169
    v_lshrrev_b32 v27, 1, v165
    v_cndmask_b32 v173, 0, v26, vcc
    v_cmp_eq_u32 vcc, 0, v165
    v_min_u32 v27, 16, v27
    v_sub_u32 v185, v165, v27
    v_cndmask_b32 v173, 0, v173, vcc
    v_mov_b32 v181, v173
    v_add_u32 v27, -1, v165
    v_ashrrev_i32 v27, 1, v27
    v_min_i32 v189, 16, v27
    v_fma_f32 v26, v28, v154, 0.5
    v_cvt_u32_f32 v26, v26
    v_max_u32 v26, 8, v26
    v_sub_u32 v26, v56, v26
    v_cmp_le_i32 vcc, 2, v26
    v_mul_f32 v27, v28, v158
    v_cvt_u32_f32 v27, v27
    v_cndmask_b32 v166, 0, v26, vcc
    v_mad_u32_u24 v26, v166, v162, v30
    v_cndmask_b32 v170, 0, v26, vcc
    v_sub_u32 v46, v56, v166
    v_mul_u32_u24 v26, v56, v162
    v_sub_u32 v26, v27, v26
    v_cmp_ge_i32 vcc, v26, v29
    v_mov_b32 v178, v170
    v_lshrrev_b32 v27, 1, v166
    v_cndmask_b32 v174, 0, v26, vcc
    v_cmp_eq_u32 vcc, 0, v166
    v_min_u32 v27, 16, v27
    v_sub_u32 v186, v166, v27
    v_cndmask_b32 v174, 0, v174, vcc
    v_mov_b32 v182, v174
    v_add_u32 v27, -1, v166
    v_ashrrev_i32 v27, 1, v27
    v_min_i32 v190, 16, v27
    v_fma_f32 v26, v28, v155, 0.5
    v_cvt_u32_f32 v26, v26
    v_max_u32 v26, 8, v26
    v_sub_u32 v26, v56, v26
    v_cmp_le_i32 vcc, 2, v26
    v_mul_f32 v27, v28, v159
    v_cvt_u32_f32 v27, v27
    v_cndmask_b32 v167, 0, v26, vcc
    v_mad_u32_u24 v26, v167, v163, v30
    v_cndmask_b32 v171, 0, v26, vcc
    v_sub_u32 v47, v56, v167
    v_mul_u32_u24 v26, v56, v163
    v_sub_u32 v26, v27, v26
    v_cmp_ge_i32 vcc, v26, v29
    v_mov_b32 v179, v171
    v_lshrrev_b32 v27, 1, v167
    v_cndmask_b32 v175, 0, v26, vcc
    v_cmp_eq_u32 vcc, 0, v167
    v_min_u32 v27, 16, v27
    v_sub_u32 v187, v167, v27
    v_cndmask_b32 v175, 0, v175, vcc
    v_mov_b32 v183, v175
    v_add_u32 v27, -1, v167
    v_ashrrev_i32 v27, 1, v27
    v_min_i32 v191, 16, v27
    s_nop 1
    v_add_u32_dpp v176, v176, v176 row_shr:1 row_mask:0xf bank_mask:0xf bound_ctrl:0
    v_add_u32_dpp v177, v177, v177 row_shr:1 row_mask:0xf bank_mask:0xf bound_ctrl:0
    v_add_u32_dpp v178, v178, v178 row_shr:1 row_mask:0xf bank_mask:0xf bound_ctrl:0
    v_add_u32_dpp v179, v179, v179 row_shr:1 row_mask:0xf bank_mask:0xf bound_ctrl:0
    v_add_u32_dpp v180, v180, v180 row_shr:1 row_mask:0xf bank_mask:0xf bound_ctrl:0
    v_add_u32_dpp v181, v181, v181 row_shr:1 row_mask:0xf bank_mask:0xf bound_ctrl:0
    v_add_u32_dpp v182, v182, v182 row_shr:1 row_mask:0xf bank_mask:0xf bound_ctrl:0
    v_add_u32_dpp v183, v183, v183 row_shr:1 row_mask:0xf bank_mask:0xf bound_ctrl:0
    v_add_u32_dpp v176, v176, v176 row_shr:2 row_mask:0xf bank_mask:0xf bound_ctrl:0
    v_add_u32_dpp v177, v177, v177 row_shr:2 row_mask:0xf bank_mask:0xf bound_ctrl:0
    v_add_u32_dpp v178, v178, v178 row_shr:2 row_mask:0xf bank_mask:0xf bound_ctrl:0
    v_add_u32_dpp v179, v179, v179 row_shr:2 row_mask:0xf bank_mask:0xf bound_ctrl:0
    v_add_u32_dpp v180, v180, v180 row_shr:2 row_mask:0xf bank_mask:0xf bound_ctrl:0
    v_add_u32_dpp v181, v181, v181 row_shr:2 row_mask:0xf bank_mask:0xf bound_ctrl:0
    v_add_u32_dpp v182, v182, v182 row_shr:2 row_mask:0xf bank_mask:0xf bound_ctrl:0
    v_add_u32_dpp v183, v183, v183 row_shr:2 row_mask:0xf bank_mask:0xf bound_ctrl:0
    v_add_u32_dpp v176, v176, v176 row_shr:4 row_mask:0xf bank_mask:0xf bound_ctrl:0
    v_add_u32_dpp v177, v177, v177 row_shr:4 row_mask:0xf bank_mask:0xf bound_ctrl:0
    v_add_u32_dpp v178, v178, v178 row_shr:4 row_mask:0xf bank_mask:0xf bound_ctrl:0
    v_add_u32_dpp v179, v179, v179 row_shr:4 row_mask:0xf bank_mask:0xf bound_ctrl:0
    v_add_u32_dpp v180, v180, v180 row_shr:4 row_mask:0xf bank_mask:0xf bound_ctrl:0
    v_add_u32_dpp v181, v181, v181 row_shr:4 row_mask:0xf bank_mask:0xf bound_ctrl:0
    v_add_u32_dpp v182, v182, v182 row_shr:4 row_mask:0xf bank_mask:0xf bound_ctrl:0
    v_add_u32_dpp v183, v183, v183 row_shr:4 row_mask:0xf bank_mask:0xf bound_ctrl:0
    v_add_u32_dpp v176, v176, v176 row_shr:8 row_mask:0xf bank_mask:0xf bound_ctrl:0
    v_add_u32_dpp v177, v177, v177 row_shr:8 row_mask:0xf bank_mask:0xf bound_ctrl:0
    v_add_u32_dpp v178, v178, v178 row_shr:8 row_mask:0xf bank_mask:0xf bound_ctrl:0
    v_add_u32_dpp v179, v179, v179 row_shr:8 row_mask:0xf bank_mask:0xf bound_ctrl:0
    v_add_u32_dpp v180, v180, v180 row_shr:8 row_mask:0xf bank_mask:0xf bound_ctrl:0
    v_add_u32_dpp v181, v181, v181 row_shr:8 row_mask:0xf bank_mask:0xf bound_ctrl:0
    v_add_u32_dpp v182, v182, v182 row_shr:8 row_mask:0xf bank_mask:0xf bound_ctrl:0
    v_add_u32_dpp v183, v183, v183 row_shr:8 row_mask:0xf bank_mask:0xf bound_ctrl:0
    v_add_u32_dpp v176, v176, v176 row_bcast:15 row_mask:0xa bank_mask:0xf
    v_add_u32_dpp v177, v177, v177 row_bcast:15 row_mask:0xa bank_mask:0xf
    v_add_u32_dpp v178, v178, v178 row_bcast:15 row_mask:0xa bank_mask:0xf
    v_add_u32_dpp v179, v179, v179 row_bcast:15 row_mask:0xa bank_mask:0xf
    v_add_u32_dpp v180, v180, v180 row_bcast:15 row_mask:0xa bank_mask:0xf
    v_add_u32_dpp v181, v181, v181 row_bcast:15 row_mask:0xa bank_mask:0xf
    v_add_u32_dpp v182, v182, v182 row_bcast:15 row_mask:0xa bank_mask:0xf
    v_add_u32_dpp v183, v183, v183 row_bcast:15 row_mask:0xa bank_mask:0xf
    v_add_u32_dpp v176, v176, v176 row_bcast:31 row_mask:0xc bank_mask:0xf
    v_add_u32_dpp v177, v177, v177 row_bcast:31 row_mask:0xc bank_mask:0xf
    v_add_u32_dpp v178, v178, v178 row_bcast:31 row_mask:0xc bank_mask:0xf
    v_add_u32_dpp v179, v179, v179 row_bcast:31 row_mask:0xc bank_mask:0xf
    v_add_u32_dpp v180, v180, v180 row_bcast:31 row_mask:0xc bank_mask:0xf
    v_add_u32_dpp v181, v181, v181 row_bcast:31 row_mask:0xc bank_mask:0xf
    v_add_u32_dpp v182, v182, v182 row_bcast:31 row_mask:0xc bank_mask:0xf
    v_add_u32_dpp v183, v183, v183 row_bcast:31 row_mask:0xc bank_mask:0xf
    s_nop 0
    v_readlane_b32 s94, v176, 63
    v_readlane_b32 s98, v180, 63
    v_readlane_b32 s95, v177, 63
    v_readlane_b32 s99, v181, 63
    v_readlane_b32 s96, v178, 63
    v_readlane_b32 s100, v182, 63
    v_readlane_b32 s97, v179, 63
    v_readlane_b32 s101, v183, 63
    s_add_u32 s95, s95, s94
    s_add_u32 s99, s99, s98
    s_add_u32 s96, s96, s95
    s_add_u32 s100, s100, s99
    s_add_u32 s97, s97, s96
    s_add_u32 s101, s101, s100
    v_add_u32 v177, s94, v177
    v_add_u32 v181, s98, v181
    v_add_u32 v178, s95, v178
    v_add_u32 v182, s99, v182
    v_add_u32 v179, s96, v179
    v_add_u32 v183, s100, v183
    v_cvt_f32_u32 v26, s101
    v_cvt_f32_u32 v27, s97
    v_rcp_f32 v26, v26
    v_mov_b32 v29, 1073741824
    v_mul_f32 v28, v26, v27
    v_sub_u32 v40, v176, v168
    v_add_u32 v40, v40, v30
    v_sub_u32 v26, v180, v172
    v_cvt_f32_u32 v26, v26
    v_cvt_f32_u32 v27, v180
    v_cmp_eq_u32 vcc, s101, v180
    v_mul_f32 v26, v26, v28
    v_mul_f32 v27, v27, v28
    v_cvt_u32_f32 v32, v26
    v_cvt_u32_f32 v36, v27
    v_cndmask_b32 v36, v36, v29, vcc
    v_cmp_ne_u32 vcc, 0, v172
    s_nop 1
    v_cndmask_b32 v32, 0, v32, vcc
    v_cndmask_b32 v36, 0, v36, vcc
    v_sub_u32 v41, v177, v169
    v_add_u32 v41, v41, v30
    v_sub_u32 v26, v181, v173
    v_cvt_f32_u32 v26, v26
    v_cvt_f32_u32 v27, v181
    v_cmp_eq_u32 vcc, s101, v181
    v_mul_f32 v26, v26, v28
    v_mul_f32 v27, v27, v28
    v_cvt_u32_f32 v33, v26
    v_cvt_u32_f32 v37, v27
    v_cndmask_b32 v37, v37, v29, vcc
    v_cmp_ne_u32 vcc, 0, v173
    s_nop 1
    v_cndmask_b32 v33, 0, v33, vcc
    v_cndmask_b32 v37, 0, v37, vcc
    v_sub_u32 v42, v178, v170
    v_add_u32 v42, v42, v30
    v_sub_u32 v26, v182, v174
    v_cvt_f32_u32 v26, v26
    v_cvt_f32_u32 v27, v182
    v_cmp_eq_u32 vcc, s101, v182
    v_mul_f32 v26, v26, v28
    v_mul_f32 v27, v27, v28
    v_cvt_u32_f32 v34, v26
    v_cvt_u32_f32 v38, v27
    v_cndmask_b32 v38, v38, v29, vcc
    v_cmp_ne_u32 vcc, 0, v174
    s_nop 1
    v_cndmask_b32 v34, 0, v34, vcc
    v_cndmask_b32 v38, 0, v38, vcc
    v_sub_u32 v43, v179, v171
    v_add_u32 v43, v43, v30
    v_sub_u32 v26, v183, v175
    v_cvt_f32_u32 v26, v26
    v_cvt_f32_u32 v27, v183
    v_cmp_eq_u32 vcc, s101, v183
    v_mul_f32 v26, v26, v28
    v_mul_f32 v27, v27, v28
    v_cvt_u32_f32 v35, v26
    v_cvt_u32_f32 v39, v27
    v_cndmask_b32 v39, v39, v29, vcc
    v_cmp_ne_u32 vcc, 0, v175
    s_nop 1
    v_cndmask_b32 v35, 0, v35, vcc
    v_cndmask_b32 v39, 0, v39, vcc
    s_cmp_lg_u32 s101, 0
    s_cbranch_scc1 L_have_takers
    v_mov_b32 v44, v56
    v_mov_b32 v45, v56
    v_mov_b32 v46, v56
    v_mov_b32 v47, v56
L_have_takers:
    s_and_b32 s87, s55, 63
    s_lshr_b32 s88, s55, 6
    v_readlane_b32 s89, v32, s87
    v_readlane_b32 s3, v33, s87
    s_cmp_eq_u32 s88, 1
    s_cselect_b32 s89, s3, s89
    v_readlane_b32 s3, v34, s87
    s_cmp_eq_u32 s88, 2
    s_cselect_b32 s89, s3, s89
    v_readlane_b32 s3, v35, s87
    s_cmp_eq_u32 s88, 3
    s_cselect_b32 s89, s3, s89
    v_readlane_b32 s90, v36, s87
    v_readlane_b32 s3, v37, s87
    s_cmp_eq_u32 s88, 1
    s_cselect_b32 s90, s3, s90
    v_readlane_b32 s3, v38, s87
    s_cmp_eq_u32 s88, 2
    s_cselect_b32 s90, s3, s90
    v_readlane_b32 s3, v39, s87
    s_cmp_eq_u32 s88, 3
    s_cselect_b32 s90, s3, s90
    v_readlane_b32 s57, v44, s87
    v_readlane_b32 s3, v45, s87
    s_cmp_eq_u32 s88, 1
    s_cselect_b32 s57, s3, s57
    v_readlane_b32 s3, v46, s87
    s_cmp_eq_u32 s88, 2
    s_cselect_b32 s57, s3, s57
    v_readlane_b32 s3, v47, s87
    s_cmp_eq_u32 s88, 3
    s_cselect_b32 s57, s3, s57
    v_readlane_b32 s91, v200, s87
    v_readlane_b32 s3, v201, s87
    s_cmp_eq_u32 s88, 1
    s_cselect_b32 s91, s3, s91
    v_readlane_b32 s3, v202, s87
    s_cmp_eq_u32 s88, 2
    s_cselect_b32 s91, s3, s91
    v_readlane_b32 s3, v203, s87
    s_cmp_eq_u32 s88, 3
    s_cselect_b32 s91, s3, s91
    s_getreg_b32 s3, hwreg(HW_REG_XCC_ID)
    s_and_b32 s3, s3, 1
    s_mul_i32 s3, s3, 2
    s_add_u32 s91, s91, s3
    s_sub_u32 s67, s56, s57
    s_nop 1
    v_sub_u32 v26, s89, v40
    v_cvt_f32_i32 v26, v26
    v_mul_f32 v26, v48, v26
    v_ceil_f32 v26, v26
    v_cvt_i32_f32 v26, v26
    v_med3_i32 v26, v26, 0, v164
    v_cmp_lt_i32 vcc, v188, v26
    s_nop 1
    v_cndmask_b32 v31, 0, v26, vcc
    v_cmp_le_i32 vcc, v184, v26
    s_nop 1
    v_cndmask_b32 v26, v31, v164, vcc
    v_sub_u32 v27, s90, v40
    v_cvt_f32_i32 v27, v27
    v_mul_f32 v27, v48, v27
    v_ceil_f32 v27, v27
    v_cvt_i32_f32 v27, v27
    v_med3_i32 v27, v27, 0, v164
    v_cmp_lt_i32 vcc, v188, v27
    s_nop 1
    v_cndmask_b32 v31, 0, v27, vcc
    v_cmp_le_i32 vcc, v184, v27
    s_nop 1
    v_cndmask_b32 v27, v31, v164, vcc
    v_cmp_gt_i32 s[36:37], v27, v26
    v_sub_u32 v31, v27, v26
    v_mad_u32_u24 v193, v31, v196, v193
    v_add_u32 v26, v26, v44
    v_add_u32 v27, v27, v44
    v_lshl_or_b32 v52, v27, 8, v26
    v_sub_u32 v26, s89, v41
    v_cvt_f32_i32 v26, v26
    v_mul_f32 v26, v49, v26
    v_ceil_f32 v26, v26
    v_cvt_i32_f32 v26, v26
    v_med3_i32 v26, v26, 0, v165
    v_cmp_lt_i32 vcc, v189, v26
    s_nop 1
    v_cndmask_b32 v31, 0, v26, vcc
    v_cmp_le_i32 vcc, v185, v26
    s_nop 1
    v_cndmask_b32 v26, v31, v165, vcc
    v_sub_u32 v27, s90, v41
    v_cvt_f32_i32 v27, v27
    v_mul_f32 v27, v49, v27
    v_ceil_f32 v27, v27
    v_cvt_i32_f32 v27, v27
    v_med3_i32 v27, v27, 0, v165
    v_cmp_lt_i32 vcc, v189, v27
    s_nop 1
    v_cndmask_b32 v31, 0, v27, vcc
    v_cmp_le_i32 vcc, v185, v27
    s_nop 1
    v_cndmask_b32 v27, v31, v165, vcc
    v_cmp_gt_i32 s[38:39], v27, v26
    v_sub_u32 v31, v27, v26
    v_mad_u32_u24 v193, v31, v197, v193
    v_add_u32 v26, v26, v45
    v_add_u32 v27, v27, v45
    v_lshl_or_b32 v53, v27, 8, v26
    v_sub_u32 v26, s89, v42
    v_cvt_f32_i32 v26, v26
    v_mul_f32 v26, v50, v26
    v_ceil_f32 v26, v26
    v_cvt_i32_f32 v26, v26
    v_med3_i32 v26, v26, 0, v166
    v_cmp_lt_i32 vcc, v190, v26
    s_nop 1
    v_cndmask_b32 v31, 0, v26, vcc
    v_cmp_le_i32 vcc, v186, v26
    s_nop 1
    v_cndmask_b32 v26, v31, v166, vcc
    v_sub_u32 v27, s90, v42
    v_cvt_f32_i32 v27, v27
    v_mul_f32 v27, v50, v27
    v_ceil_f32 v27, v27
    v_cvt_i32_f32 v27, v27
    v_med3_i32 v27, v27, 0, v166
    v_cmp_lt_i32 vcc, v190, v27
    s_nop 1
    v_cndmask_b32 v31, 0, v27, vcc
    v_cmp_le_i32 vcc, v186, v27
    s_nop 1
    v_cndmask_b32 v27, v31, v166, vcc
    v_cmp_gt_i32 s[40:41], v27, v26
    v_sub_u32 v31, v27, v26
    v_mad_u32_u24 v193, v31, v198, v193
    v_add_u32 v26, v26, v46
    v_add_u32 v27, v27, v46
    v_lshl_or_b32 v54, v27, 8, v26
    v_sub_u32 v26, s89, v43
    v_cvt_f32_i32 v26, v26
    v_mul_f32 v26, v51, v26
    v_ceil_f32 v26, v26
    v_cvt_i32_f32 v26, v26
    v_med3_i32 v26, v26, 0, v167
    v_cmp_lt_i32 vcc, v191, v26
    s_nop 1
    v_cndmask_b32 v31, 0, v26, vcc
    v_cmp_le_i32 vcc, v187, v26
    s_nop 1
    v_cndmask_b32 v26, v31, v167, vcc
    v_sub_u32 v27, s90, v43
    v_cvt_f32_i32 v27, v27
    v_mul_f32 v27, v51, v27
    v_ceil_f32 v27, v27
    v_cvt_i32_f32 v27, v27
    v_med3_i32 v27, v27, 0, v167
    v_cmp_lt_i32 vcc, v191, v27
    s_nop 1
    v_cndmask_b32 v31, 0, v27, vcc
    v_cmp_le_i32 vcc, v187, v27
    s_nop 1
    v_cndmask_b32 v27, v31, v167, vcc
    v_cmp_gt_i32 s[42:43], v27, v26
    v_sub_u32 v31, v27, v26
    v_mad_u32_u24 v193, v31, v199, v193
    v_add_u32 v26, v26, v47
    v_add_u32 v27, v27, v47
    v_lshl_or_b32 v55, v27, 8, v26
    s_mov_b32 s74, 0
    s_nop 1
    v_add_u32_dpp v193, v193, v193 row_shr:1 row_mask:0xf bank_mask:0xf bound_ctrl:0
    s_nop 1
    v_add_u32_dpp v193, v193, v193 row_shr:2 row_mask:0xf bank_mask:0xf bound_ctrl:0
    s_nop 1
    v_add_u32_dpp v193, v193, v193 row_shr:4 row_mask:0xf bank_mask:0xf bound_ctrl:0
    s_nop 1
    v_add_u32_dpp v193, v193, v193 row_shr:8 row_mask:0xf bank_mask:0xf bound_ctrl:0
    s_nop 1
    v_add_u32_dpp v193, v193, v193 row_bcast:15 row_mask:0xa bank_mask:0xf
    s_nop 1
    v_add_u32_dpp v193, v193, v193 row_bcast:31 row_mask:0xc bank_mask:0xf
    v_rcp_f32 v192, v192
    v_readlane_b32 s87, v193, 63
    s_lshr_b32 s89, s87, 16
    s_and_b32 s87, s87, 0xffff
    s_max_u32 s90, s57, 8
    s_add_u32 s89, s89, s90
    s_mul_i32 s90, s90, s91
    s_add_u32 s87, s87, s90
    s_cmp_lg_u32 s67, 0
    s_cselect_b32 s88, 1024, 0
    s_add_u32 s87, s87, s88
    s_bcnt1_i32_b64 s88, s[36:37]
    s_mul_i32 s88, s88, 256
    s_add_u32 s87, s87, s88
    s_bcnt1_i32_b64 s88, s[38:39]
    s_mul_i32 s88, s88, 256
    s_add_u32 s87, s87, s88
    s_bcnt1_i32_b64 s88, s[40:41]
    s_mul_i32 s88, s88, 256
    s_add_u32 s87, s87, s88
    s_bcnt1_i32_b64 s88, s[42:43]
    s_mul_i32 s88, s88, 256
    s_add_u32 s87, s87, s88
    s_sub_u32 s88, s89, s52
    s_add_u32 s88, s88, 3
    s_and_b32 s88, s88, -4
    s_mov_b32 s92, s88
    s_lshr_b32 s87, s87, 2
    v_cvt_f32_u32 v26, s87
    v_mul_f32 v26, v26, v192
    v_mov_b32 v252, v26
    s_mov_b32 s79, s74
    v_mov_b32 v27, 0x44466666
    v_subrev_f32 v28, 0x3f1eb852, v252
    v_max_f32 v28, 0, v28
    v_min_f32 v28, 0x3d8f5c29, v28
    v_fmac_f32 v27, 0x45092492, v28
    v_subrev_f32 v28, 0x3f30a3d7, v252
    v_max_f32 v28, 0, v28
    v_min_f32 v28, 0x3d8f5c29, v28
    v_fmac_f32 v27, 0x44e49249, v28
    v_subrev_f32 v28, 0x3f428f5c, v252
    v_max_f32 v28, 0, v28
    v_min_f32 v28, 0x3d23d70a, v28
    v_fmac_f32 v27, 0x45200000, v28
    v_subrev_f32 v28, 0x3f4ccccd, v252
    v_max_f32 v28, 0, v28
    v_min_f32 v28, 0x3ca3d70a, v28
    v_fmac_f32 v27, 0x45a00000, v28
    v_subrev_f32 v28, 0x3f51eb85, v252
    v_max_f32 v28, 0, v28
    v_min_f32 v28, 0x3d8f5c29, v28
    v_fmac_f32 v27, 0x44e49249, v28
    v_subrev_f32 v28, 0x3f63d70a, v252
    v_max_f32 v28, 0, v28
    v_min_f32 v28, 0x3cf5c28f, v28
    v_fmac_f32 v27, 0x45855555, v28
    v_subrev_f32 v28, 0x3f6b851f, v252
    v_max_f32 v28, 0, v28
    v_min_f32 v28, 0x3cf5c28f, v28
    v_fmac_f32 v27, 0x46055555, v28
    v_subrev_f32 v28, 0x3f733333, v252
    v_max_f32 v28, 0, v28
    v_min_f32 v28, 0x3de147ae, v28
    v_fmac_f32 v27, 0x4491745d, v28
    v_subrev_f32 v28, 0x3f87ae14, v252
    v_max_f32 v28, 0, v28
    v_min_f32 v28, 0x3e3851ec, v28
    v_fmac_f32 v27, 0x4431c71c, v28
    v_subrev_f32 v28, 0x3f9eb852, v252
    v_max_f32 v28, 0, v28
    v_min_f32 v28, 0x3d75c28f, v28
    v_fmac_f32 v27, 0x45055555, v28
    v_subrev_f32 v28, 0x3fa66666, v252
    v_max_f32 v28, 0, v28
    v_min_f32 v28, 0x3d4ccccd, v28
    v_fmac_f32 v27, 0x45f00000, v28
    v_subrev_f32 v28, 0x3faccccd, v252
    v_max_f32 v28, 0, v28
    v_min_f32 v28, 0x3e19999a, v28
    v_fmac_f32 v27, 0x45d55555, v28
    v_cvt_u32_f32 v27, v27
    s_nop 0
    v_readfirstlane_b32 s53, v27
    s_max_u32 s53, s53, s79
    s_lshl_b32 s54, s52, 6
    s_add_u32 m0, s80, 16384
    s_nop 0
    buffer_load_dwordx4 v14, s[4:7], s70 offen nt lds
    buffer_load_dwordx4 v15, s[4:7], s70 offen offset:1024 nt lds
    buffer_load_dwordx4 v16, s[4:7], s70 offen offset:2048 nt lds
    buffer_load_dwordx4 v17, s[4:7], s70 offen offset:3072 nt lds
    s_add_u32 m0, s80, 20480
    s_nop 0
    buffer_load_dwordx4 v14, s[4:7], s71 offen nt lds
    buffer_load_dwordx4 v15, s[4:7], s71 offen offset:1024 nt lds
    buffer_load_dwordx4 v16, s[4:7], s71 offen offset:2048 nt lds
    buffer_load_dwordx4 v17, s[4:7], s71 offen offset:3072 nt lds
    s_add_u32 m0, s80, 24576
    s_nop 0
    buffer_load_dwordx4 v18, s[8:11], s70 offen nt lds
    buffer_load_dwordx4 v19, s[8:11], s70 offen offset:1024 nt lds
    buffer_load_dwordx4 v20, s[8:11], s70 offen offset:2048 nt lds
    buffer_load_dwordx4 v21, s[8:11], s70 offen offset:3072 nt lds
    s_add_u32 m0, s80, 28672
    s_nop 0
    buffer_load_dwordx4 v18, s[8:11], s71 offen nt lds
    buffer_load_dwordx4 v19, s[8:11], s71 offen offset:1024 nt lds
    buffer_load_dwordx4 v20, s[8:11], s71 offen offset:2048 nt lds
    buffer_load_dwordx4 v21, s[8:11], s71 offen offset:3072 nt lds
    s_mov_b64 s[44:45], s[36:37]
    s_mov_b64 s[46:47], s[38:39]
    s_mov_b64 s[48:49], s[40:41]
    s_mov_b64 s[50:51], s[42:43]
    s_or_b64 s[88:89], s[36:37], s[38:39]
    s_or_b64 s[90:91], s[40:41], s[42:43]
    s_or_b64 s[88:89], s[88:89], s[90:91]
    s_cselect_b32 s87, 1, 0
    s_mov_b32 s59, s87
    s_add_u32 s60, s52, 4
    s_mov_b32 s61, 8
    s_mov_b32 s0, 0x100000
    s_mov_b32 s56, 0x7fff
    s_mov_b32 s1, 0x7fff
    s_mov_b32 s72, s52
    s_mov_b32 s73, 8
    s_mov_b32 s75, s55
    s_mov_b32 s76, s58
    s_mov_b32 s65, s74
    s_mov_b32 s66, s74
    s_mov_b32 s77, s74
    s_mov_b32 s78, s74
    s_mov_b32 s84, s74
    s_mov_b32 s85, s74
    s_mov_b32 s86, s74
    s_mov_b32 s20, s74
    s_mov_b32 s21, s74
    s_mov_b32 s22, s74
    s_mov_b32 s23, s74
    s_mov_b32 s82, s74
    s_mov_b32 s93, s74
    s_cmp_eq_u32 s52, 0
    s_cselect_b32 s87, 4, 7
    s_mov_b32 s83, s87
    s_mul_i32 s87, s57, 133
    s_lshr_b32 s87, s87, 10
    s_add_u32 s87, s87, 1
    s_cmp_lg_u32 s67, 0
    s_cselect_b32 s82, s87, 0
    v_mov_b32 v64, 0
    v_mov_b32 v65, 0
    v_mov_b32 v66, 0
    v_mov_b32 v67, 0
    v_mov_b32 v68, 0
    v_mov_b32 v69, 0
    v_mov_b32 v70, 0
    v_mov_b32 v71, 0
    v_mov_b32 v72, 0
    v_mov_b32 v73, 0
    v_mov_b32 v74, 0
    v_mov_b32 v75, 0
    v_mov_b32 v76, 0
    v_mov_b32 v77, 0
    v_mov_b32 v78, 0
    v_mov_b32 v79, 0
    v_mov_b32 v80, 0
    v_mov_b32 v81, 0
    v_mov_b32 v82, 0
    v_mov_b32 v83, 0
    v_mov_b32 v84, 0
    v_mov_b32 v85, 0
    v_mov_b32 v86, 0
    v_mov_b32 v87, 0
    v_mov_b32 v88, 0
    v_mov_b32 v89, 0
    v_mov_b32 v90, 0
    v_mov_b32 v91, 0
    v_mov_b32 v92, 0
    v_mov_b32 v93, 0
    v_mov_b32 v94, 0
    v_mov_b32 v95, 0
    v_mov_b32 v96, 0
    v_mov_b32 v97, 0
    v_mov_b32 v98, 0
    v_mov_b32 v99, 0
    v_mov_b32 v100, 0
    v_mov_b32 v101, 0
    v_mov_b32 v102, 0
    v_mov_b32 v103, 0
    v_mov_b32 v104, 0
    v_mov_b32 v105, 0
    v_mov_b32 v106, 0
    v_mov_b32 v107, 0
    v_mov_b32 v108, 0
    v_mov_b32 v109, 0
    v_mov_b32 v110, 0
    v_mov_b32 v111, 0
    v_mov_b32 v112, 0
    v_mov_b32 v113, 0
    v_mov_b32 v114, 0
    v_mov_b32 v115, 0
    v_mov_b32 v116, 0
    v_mov_b32 v117, 0
    v_mov_b32 v118, 0
    v_mov_b32 v119, 0
    v_mov_b32 v120, 0
    v_mov_b32 v121, 0
    v_mov_b32 v122, 0
    v_mov_b32 v123, 0
    v_mov_b32 v124, 0
    v_mov_b32 v125, 0
    v_mov_b32 v126, 0
    v_mov_b32 v127, 0
    v_mov_b32 v24, 0xff61b1e6
    v_mov_b32 v25, 0
    s_waitcnt lgkmcnt(0)
    s_barrier
.p2align 6
L_tile:
    s_mov_b32 s56, s1
    s_mov_b32 s1, 0x7fff
    s_cmp_eq_u32 s65, 1
    s_cbranch_scc1 L_adv_claim
    s_add_u32 s60, s60, 4
    s_cmp_lt_u32 s60, s61
    s_cbranch_scc0 L_adv_slow
L_adv_done:
    s_add_u32 s87, s60, 4
    s_cmp_ge_u32 s87, s61
    s_cselect_b32 s87, s65, 0
    s_cmp_eq_u32 s87, 1
    s_cselect_b32 s79, 3584, s79
    s_max_u32 s53, s53, s79
    s_lshl_b32 s87, s60, 3
    s_add_u32 s87, s87, s63
    s_buffer_load_dwordx2 s[68:69], s[16:19], s87
L_adv_skip:
    s_cmp_lg_u32 s78, 0
    s_waitcnt vmcnt(24)
    s_cbranch_scc1 L_qcopy
L_qcopy_ret:
    ds_read_b128 v[152:155], v2
    ds_read_b128 v[156:159], v3
    ds_read_b128 v[160:163], v4
    ds_read_b128 v[164:167], v5
    ds_read_b128 v[168:171], v6
    ds_read_b128 v[172:175], v7
    ds_read_b128 v[176:179], v8
    ds_read_b128 v[180:183], v9
    s_waitcnt lgkmcnt(7)
    v_mfma_f32_32x32x16_bf16 v[128:143], v[152:155], v[216:219], 0
    s_waitcnt lgkmcnt(6)
    v_mfma_f32_32x32x16_bf16 v[128:143], v[156:159], v[220:223], v[128:143]
    s_waitcnt lgkmcnt(5)
    v_mfma_f32_32x32x16_bf16 v[128:143], v[160:163], v[224:227], v[128:143]
    s_waitcnt lgkmcnt(4)
    v_mfma_f32_32x32x16_bf16 v[128:143], v[164:167], v[228:231], v[128:143]
    s_waitcnt lgkmcnt(3)
    v_mfma_f32_32x32x16_bf16 v[128:143], v[168:171], v[232:235], v[128:143]
    s_waitcnt lgkmcnt(2)
    v_mfma_f32_32x32x16_bf16 v[128:143], v[172:175], v[236:239], v[128:143]
    s_waitcnt lgkmcnt(1)
    v_mfma_f32_32x32x16_bf16 v[128:143], v[176:179], v[240:243], v[128:143]
    s_waitcnt lgkmcnt(0)
    v_mfma_f32_32x32x16_bf16 v[128:143], v[180:183], v[244:247], v[128:143]
L_nc1:
    s_cmp_lg_u32 s66, 0
    s_cbranch_scc1 L_qstage
L_qstage_ret:
    s_lshl_b32 s87, s60, 5
    s_add_u32 s87, s87, 16
    s_cmp_ge_u32 s87, s0
    s_cselect_b32 s69, 0x4000, s69
    s_lshl_b32 s70, s68, 16
    s_lshl_b32 s71, s69, 16
    s_add_u32 s70, s70, s62
    s_add_u32 s71, s71, s62
    s_and_b32 s54, s54, 255
    s_add_u32 s54, s54, s53
    s_lshr_b32 s87, s54, 8
    s_cmp_gt_u32 s87, 8
    s_cbranch_scc1 L_wt_15
    s_cmp_gt_u32 s87, 5
    s_cbranch_scc1 L_wt_16
    s_cmp_gt_u32 s87, 3
    s_cbranch_scc1 L_wt_17
    s_cmp_gt_u32 s87, 2
    s_cbranch_scc1 L_win3_3
    s_branch L_win2_2
L_wt_17:
    s_cmp_gt_u32 s87, 4
    s_cbranch_scc1 L_win5_5
    s_branch L_win4_4
L_wt_16:
    s_cmp_gt_u32 s87, 7
    s_cbranch_scc1 L_win8_8
    s_cmp_gt_u32 s87, 6
    s_cbranch_scc1 L_win7_7
    s_branch L_win6_6
L_wt_15:
    s_cmp_gt_u32 s87, 11
    s_cbranch_scc1 L_wt_22
    s_cmp_gt_u32 s87, 10
    s_cbranch_scc1 L_win11_11
    s_cmp_gt_u32 s87, 9
    s_cbranch_scc1 L_win10_10
    s_branch L_win9_9
L_wt_22:
    s_cmp_gt_u32 s87, 13
    s_cbranch_scc1 L_win14_14
    s_cmp_gt_u32 s87, 12
    s_cbranch_scc1 L_win13_13
    s_branch L_win12_12
L_win2_2:
    s_add_u32 m0, s80, 0
    s_waitcnt vmcnt(1)
    buffer_load_dwordx4 v14, s[4:7], s70 offen nt lds
    s_waitcnt vmcnt(1)
    buffer_load_dwordx4 v15, s[4:7], s70 offen offset:1024 nt lds
    s_waitcnt vmcnt(1)
    buffer_load_dwordx4 v16, s[4:7], s70 offen offset:2048 nt lds
    s_waitcnt vmcnt(1)
    buffer_load_dwordx4 v17, s[4:7], s70 offen offset:3072 nt lds
    s_add_u32 m0, s80, 4096
    s_waitcnt vmcnt(1)
    buffer_load_dwordx4 v14, s[4:7], s71 offen nt lds
    s_waitcnt vmcnt(1)
    buffer_load_dwordx4 v15, s[4:7], s71 offen offset:1024 nt lds
    s_waitcnt vmcnt(1)
    buffer_load_dwordx4 v16, s[4:7], s71 offen offset:2048 nt lds
    s_waitcnt vmcnt(1)
    buffer_load_dwordx4 v17, s[4:7], s71 offen offset:3072 nt lds
    s_branch L_win_done_1
L_win3_3:
    s_add_u32 m0, s80, 0
    s_waitcnt vmcnt(2)
    buffer_load_dwordx4 v14, s[4:7], s70 offen nt lds
    s_waitcnt vmcnt(2)
    buffer_load_dwordx4 v15, s[4:7], s70 offen offset:1024 nt lds
    s_waitcnt vmcnt(2)
    buffer_load_dwordx4 v16, s[4:7], s70 offen offset:2048 nt lds
    s_waitcnt vmcnt(2)
    buffer_load_dwordx4 v17, s[4:7], s70 offen offset:3072 nt lds
    s_add_u32 m0, s80, 4096
    s_waitcnt vmcnt(2)
    buffer_load_dwordx4 v14, s[4:7], s71 offen nt lds
    s_waitcnt vmcnt(2)
    buffer_load_dwordx4 v15, s[4:7], s71 offen offset:1024 nt lds
    s_waitcnt vmcnt(2)
    buffer_load_dwordx4 v16, s[4:7], s71 offen offset:2048 nt lds
    s_waitcnt vmcnt(2)
    buffer_load_dwordx4 v17, s[4:7], s71 offen offset:3072 nt lds
    s_branch L_win_done_1
L_win4_4:
    s_add_u32 m0, s80, 0
    s_waitcnt vmcnt(3)
    buffer_load_dwordx4 v14, s[4:7], s70 offen nt lds
    s_waitcnt vmcnt(3)
    buffer_load_dwordx4 v15, s[4:7], s70 offen offset:1024 nt lds
    s_waitcnt vmcnt(3)
    buffer_load_dwordx4 v16, s[4:7], s70 offen offset:2048 nt lds
    s_waitcnt vmcnt(3)
    buffer_load_dwordx4 v17, s[4:7], s70 offen offset:3072 nt lds
    s_add_u32 m0, s80, 4096
    s_waitcnt vmcnt(3)
    buffer_load_dwordx4 v14, s[4:7], s71 offen nt lds
    s_waitcnt vmcnt(3)
    buffer_load_dwordx4 v15, s[4:7], s71 offen offset:1024 nt lds
    s_waitcnt vmcnt(3)
    buffer_load_dwordx4 v16, s[4:7], s71 offen offset:2048 nt lds
    s_waitcnt vmcnt(3)
    buffer_load_dwordx4 v17, s[4:7], s71 offen offset:3072 nt lds
    s_branch L_win_done_1
L_win5_5:
    s_add_u32 m0, s80, 0
    s_waitcnt vmcnt(4)
    buffer_load_dwordx4 v14, s[4:7], s70 offen nt lds
    s_waitcnt vmcnt(4)
    buffer_load_dwordx4 v15, s[4:7], s70 offen offset:1024 nt lds
    s_waitcnt vmcnt(4)
    buffer_load_dwordx4 v16, s[4:7], s70 offen offset:2048 nt lds
    s_waitcnt vmcnt(4)
    buffer_load_dwordx4 v17, s[4:7], s70 offen offset:3072 nt lds
    s_add_u32 m0, s80, 4096
    s_waitcnt vmcnt(4)
    buffer_load_dwordx4 v14, s[4:7], s71 offen nt lds
    s_waitcnt vmcnt(4)
    buffer_load_dwordx4 v15, s[4:7], s71 offen offset:1024 nt lds
    s_waitcnt vmcnt(4)
    buffer_load_dwordx4 v16, s[4:7], s71 offen offset:2048 nt lds
    s_waitcnt vmcnt(4)
    buffer_load_dwordx4 v17, s[4:7], s71 offen offset:3072 nt lds
    s_branch L_win_done_1
L_win6_6:
    s_add_u32 m0, s80, 0
    s_waitcnt vmcnt(5)
    buffer_load_dwordx4 v14, s[4:7], s70 offen nt lds
    s_waitcnt vmcnt(5)
    buffer_load_dwordx4 v15, s[4:7], s70 offen offset:1024 nt lds
    s_waitcnt vmcnt(5)
    buffer_load_dwordx4 v16, s[4:7], s70 offen offset:2048 nt lds
    s_waitcnt vmcnt(5)
    buffer_load_dwordx4 v17, s[4:7], s70 offen offset:3072 nt lds
    s_add_u32 m0, s80, 4096
    s_waitcnt vmcnt(5)
    buffer_load_dwordx4 v14, s[4:7], s71 offen nt lds
    s_waitcnt vmcnt(5)
    buffer_load_dwordx4 v15, s[4:7], s71 offen offset:1024 nt lds
    s_waitcnt vmcnt(5)
    buffer_load_dwordx4 v16, s[4:7], s71 offen offset:2048 nt lds
    s_waitcnt vmcnt(5)
    buffer_load_dwordx4 v17, s[4:7], s71 offen offset:3072 nt lds
    s_branch L_win_done_1
L_win7_7:
    s_add_u32 m0, s80, 0
    s_waitcnt vmcnt(6)
    buffer_load_dwordx4 v14, s[4:7], s70 offen nt lds
    s_waitcnt vmcnt(6)
    buffer_load_dwordx4 v15, s[4:7], s70 offen offset:1024 nt lds
    s_waitcnt vmcnt(6)
    buffer_load_dwordx4 v16, s[4:7], s70 offen offset:2048 nt lds
    s_waitcnt vmcnt(6)
    buffer_load_dwordx4 v17, s[4:7], s70 offen offset:3072 nt lds
    s_add_u32 m0, s80, 4096
    s_waitcnt vmcnt(6)
    buffer_load_dwordx4 v14, s[4:7], s71 offen nt lds
    s_waitcnt vmcnt(6)
    buffer_load_dwordx4 v15, s[4:7], s71 offen offset:1024 nt lds
    s_waitcnt vmcnt(6)
    buffer_load_dwordx4 v16, s[4:7], s71 offen offset:2048 nt lds
    s_waitcnt vmcnt(6)
    buffer_load_dwordx4 v17, s[4:7], s71 offen offset:3072 nt lds
    s_branch L_win_done_1
L_win8_8:
    s_add_u32 m0, s80, 0
    s_waitcnt vmcnt(7)
    buffer_load_dwordx4 v14, s[4:7], s70 offen nt lds
    s_waitcnt vmcnt(7)
    buffer_load_dwordx4 v15, s[4:7], s70 offen offset:1024 nt lds
    s_waitcnt vmcnt(7)
    buffer_load_dwordx4 v16, s[4:7], s70 offen offset:2048 nt lds
    s_waitcnt vmcnt(7)
    buffer_load_dwordx4 v17, s[4:7], s70 offen offset:3072 nt lds
    s_add_u32 m0, s80, 4096
    s_waitcnt vmcnt(7)
    buffer_load_dwordx4 v14, s[4:7], s71 offen nt lds
    s_waitcnt vmcnt(7)
    buffer_load_dwordx4 v15, s[4:7], s71 offen offset:1024 nt lds
    s_waitcnt vmcnt(7)
    buffer_load_dwordx4 v16, s[4:7], s71 offen offset:2048 nt lds
    s_waitcnt vmcnt(7)
    buffer_load_dwordx4 v17, s[4:7], s71 offen offset:3072 nt lds
    s_branch L_win_done_1
L_win9_9:
    s_add_u32 m0, s80, 0
    s_waitcnt vmcnt(8)
    buffer_load_dwordx4 v14, s[4:7], s70 offen nt lds
    s_waitcnt vmcnt(8)
    buffer_load_dwordx4 v15, s[4:7], s70 offen offset:1024 nt lds
    s_waitcnt vmcnt(8)
    buffer_load_dwordx4 v16, s[4:7], s70 offen offset:2048 nt lds
    s_waitcnt vmcnt(8)
    buffer_load_dwordx4 v17, s[4:7], s70 offen offset:3072 nt lds
    s_add_u32 m0, s80, 4096
    s_waitcnt vmcnt(8)
    buffer_load_dwordx4 v14, s[4:7], s71 offen nt lds
    s_waitcnt vmcnt(8)
    buffer_load_dwordx4 v15, s[4:7], s71 offen offset:1024 nt lds
    s_waitcnt vmcnt(8)
    buffer_load_dwordx4 v16, s[4:7], s71 offen offset:2048 nt lds
    s_waitcnt vmcnt(8)
    buffer_load_dwordx4 v17, s[4:7], s71 offen offset:3072 nt lds
    s_branch L_win_done_1
L_win10_10:
    s_add_u32 m0, s80, 0
    s_waitcnt vmcnt(9)
    buffer_load_dwordx4 v14, s[4:7], s70 offen nt lds
    s_waitcnt vmcnt(9)
    buffer_load_dwordx4 v15, s[4:7], s70 offen offset:1024 nt lds
    s_waitcnt vmcnt(9)
    buffer_load_dwordx4 v16, s[4:7], s70 offen offset:2048 nt lds
    s_waitcnt vmcnt(9)
    buffer_load_dwordx4 v17, s[4:7], s70 offen offset:3072 nt lds
    s_add_u32 m0, s80, 4096
    s_waitcnt vmcnt(9)
    buffer_load_dwordx4 v14, s[4:7], s71 offen nt lds
    s_waitcnt vmcnt(9)
    buffer_load_dwordx4 v15, s[4:7], s71 offen offset:1024 nt lds
    s_waitcnt vmcnt(9)
    buffer_load_dwordx4 v16, s[4:7], s71 offen offset:2048 nt lds
    s_waitcnt vmcnt(9)
    buffer_load_dwordx4 v17, s[4:7], s71 offen offset:3072 nt lds
    s_branch L_win_done_1
L_win11_11:
    s_add_u32 m0, s80, 0
    s_waitcnt vmcnt(10)
    buffer_load_dwordx4 v14, s[4:7], s70 offen nt lds
    s_waitcnt vmcnt(10)
    buffer_load_dwordx4 v15, s[4:7], s70 offen offset:1024 nt lds
    s_waitcnt vmcnt(10)
    buffer_load_dwordx4 v16, s[4:7], s70 offen offset:2048 nt lds
    s_waitcnt vmcnt(10)
    buffer_load_dwordx4 v17, s[4:7], s70 offen offset:3072 nt lds
    s_add_u32 m0, s80, 4096
    s_waitcnt vmcnt(10)
    buffer_load_dwordx4 v14, s[4:7], s71 offen nt lds
    s_waitcnt vmcnt(10)
    buffer_load_dwordx4 v15, s[4:7], s71 offen offset:1024 nt lds
    s_waitcnt vmcnt(10)
    buffer_load_dwordx4 v16, s[4:7], s71 offen offset:2048 nt lds
    s_waitcnt vmcnt(10)
    buffer_load_dwordx4 v17, s[4:7], s71 offen offset:3072 nt lds
    s_branch L_win_done_1
L_win12_12:
    s_add_u32 m0, s80, 0
    s_waitcnt vmcnt(11)
    buffer_load_dwordx4 v14, s[4:7], s70 offen nt lds
    s_waitcnt vmcnt(11)
    buffer_load_dwordx4 v15, s[4:7], s70 offen offset:1024 nt lds
    s_waitcnt vmcnt(11)
    buffer_load_dwordx4 v16, s[4:7], s70 offen offset:2048 nt lds
    s_waitcnt vmcnt(11)
    buffer_load_dwordx4 v17, s[4:7], s70 offen offset:3072 nt lds
    s_add_u32 m0, s80, 4096
    s_waitcnt vmcnt(11)
    buffer_load_dwordx4 v14, s[4:7], s71 offen nt lds
    s_waitcnt vmcnt(11)
    buffer_load_dwordx4 v15, s[4:7], s71 offen offset:1024 nt lds
    s_waitcnt vmcnt(11)
    buffer_load_dwordx4 v16, s[4:7], s71 offen offset:2048 nt lds
    s_waitcnt vmcnt(11)
    buffer_load_dwordx4 v17, s[4:7], s71 offen offset:3072 nt lds
    s_branch L_win_done_1
L_win13_13:
    s_add_u32 m0, s80, 0
    s_waitcnt vmcnt(12)
    buffer_load_dwordx4 v14, s[4:7], s70 offen nt lds
    s_waitcnt vmcnt(12)
    buffer_load_dwordx4 v15, s[4:7], s70 offen offset:1024 nt lds
    s_waitcnt vmcnt(12)
    buffer_load_dwordx4 v16, s[4:7], s70 offen offset:2048 nt lds
    s_waitcnt vmcnt(12)
    buffer_load_dwordx4 v17, s[4:7], s70 offen offset:3072 nt lds
    s_add_u32 m0, s80, 4096
    s_waitcnt vmcnt(12)
    buffer_load_dwordx4 v14, s[4:7], s71 offen nt lds
    s_waitcnt vmcnt(12)
    buffer_load_dwordx4 v15, s[4:7], s71 offen offset:1024 nt lds
    s_waitcnt vmcnt(12)
    buffer_load_dwordx4 v16, s[4:7], s71 offen offset:2048 nt lds
    s_waitcnt vmcnt(12)
    buffer_load_dwordx4 v17, s[4:7], s71 offen offset:3072 nt lds
    s_branch L_win_done_1
L_win14_14:
    s_add_u32 m0, s80, 0
    s_nop 0
    buffer_load_dwordx4 v14, s[4:7], s70 offen nt lds
    buffer_load_dwordx4 v15, s[4:7], s70 offen offset:1024 nt lds
    buffer_load_dwordx4 v16, s[4:7], s70 offen offset:2048 nt lds
    buffer_load_dwordx4 v17, s[4:7], s70 offen offset:3072 nt lds
    s_add_u32 m0, s80, 4096
    s_nop 0
    buffer_load_dwordx4 v14, s[4:7], s71 offen nt lds
    buffer_load_dwordx4 v15, s[4:7], s71 offen offset:1024 nt lds
    buffer_load_dwordx4 v16, s[4:7], s71 offen offset:2048 nt lds
    buffer_load_dwordx4 v17, s[4:7], s71 offen offset:3072 nt lds
L_win_done_1:
    s_lshl_b32 s87, s72, 5
    s_sub_i32 s87, s76, s87
    s_cmp_lt_i32 s87, 32
    s_cbranch_scc1 L_mask
L_mask_ret:
    v_max3_f32 v26, v128, v129, v130
    v_max3_f32 v27, v131, v132, v133
    v_max3_f32 v28, v134, v135, v136
    v_max3_f32 v29, v137, v138, v139
    v_max3_f32 v30, v140, v141, v142
    v_max3_f32 v26, v26, v27, v143
    v_max3_f32 v28, v28, v29, v30
    v_max_f32 v26, v26, v28
    v_mov_b32 v27, v26
    s_nop 1
    v_permlane32_swap_b32 v26, v27
    s_nop 1
    v_max_f32 v26, v26, v27
    v_mul_f32 v26, s81, v26
    v_max_f32 v26, v26, v24
    v_sub_f32 v23, v24, v26
    v_exp_f32 v23, v23
    v_mov_b32 v24, v26
    v_fma_f32 v128, v128, s81, -v24
    v_fma_f32 v129, v129, s81, -v24
    v_fma_f32 v130, v130, s81, -v24
    v_fma_f32 v131, v131, s81, -v24
    v_fma_f32 v132, v132, s81, -v24
    v_fma_f32 v133, v133, s81, -v24
    v_fma_f32 v134, v134, s81, -v24
    v_fma_f32 v135, v135, s81, -v24
    v_fma_f32 v136, v136, s81, -v24
    v_fma_f32 v137, v137, s81, -v24
    v_fma_f32 v138, v138, s81, -v24
    v_fma_f32 v139, v139, s81, -v24
    v_fma_f32 v140, v140, s81, -v24
    v_fma_f32 v141, v141, s81, -v24
    v_fma_f32 v142, v142, s81, -v24
    v_fma_f32 v143, v143, s81, -v24
    v_exp_f32 v128, v128
    v_exp_f32 v129, v129
    v_exp_f32 v130, v130
    v_exp_f32 v131, v131
    v_exp_f32 v132, v132
    v_exp_f32 v133, v133
    v_exp_f32 v134, v134
    v_exp_f32 v135, v135
    v_exp_f32 v136, v136
    v_exp_f32 v137, v137
    v_exp_f32 v138, v138
    v_exp_f32 v139, v139
    v_exp_f32 v140, v140
    v_exp_f32 v141, v141
    v_exp_f32 v142, v142
    v_exp_f32 v143, v143
    s_waitcnt vmcnt(24)
    ds_read_b64_tr_b16 v[184:185], v10
    ds_read_b64_tr_b16 v[186:187], v10 offset:2048
    ds_read_b64_tr_b16 v[188:189], v11
    ds_read_b64_tr_b16 v[190:191], v11 offset:2048
    ds_read_b64_tr_b16 v[192:193], v12
    ds_read_b64_tr_b16 v[194:195], v12 offset:2048
    ds_read_b64_tr_b16 v[196:197], v13
    ds_read_b64_tr_b16 v[198:199], v13 offset:2048
    ds_read_b64_tr_b16 v[200:201], v10 offset:4096
    ds_read_b64_tr_b16 v[202:203], v10 offset:6144
    ds_read_b64_tr_b16 v[204:205], v11 offset:4096
    ds_read_b64_tr_b16 v[206:207], v11 offset:6144
    ds_read_b64_tr_b16 v[208:209], v12 offset:4096
    ds_read_b64_tr_b16 v[210:211], v12 offset:6144
    ds_read_b64_tr_b16 v[212:213], v13 offset:4096
    ds_read_b64_tr_b16 v[214:215], v13 offset:6144
    v_cvt_pk_bf16_f32 v144, v128, v129
    v_cvt_pk_bf16_f32 v145, v130, v131
    v_cvt_pk_bf16_f32 v146, v132, v133
    v_cvt_pk_bf16_f32 v147, v134, v135
    v_cvt_pk_bf16_f32 v148, v136, v137
    v_cvt_pk_bf16_f32 v149, v138, v139
    v_cvt_pk_bf16_f32 v150, v140, v141
    v_cvt_pk_bf16_f32 v151, v142, v143
    v_mul_f32 v25, v25, v23
    v_add_f32 v26, v128, v129
    v_add_f32 v27, v130, v131
    v_add_f32 v26, v26, v132
    v_add_f32 v27, v27, v133
    v_add_f32 v26, v26, v134
    v_add_f32 v27, v27, v135
    v_add_f32 v26, v26, v136
    v_add_f32 v27, v27, v137
    v_add_f32 v26, v26, v138
    v_add_f32 v27, v27, v139
    v_add_f32 v26, v26, v140
    v_add_f32 v27, v27, v141
    v_add_f32 v26, v26, v142
    v_add_f32 v27, v27, v143
    v_add_f32 v26, v26, v27
    v_add_f32 v25, v25, v26
    v_mul_f32 v64, v64, v23
    v_mul_f32 v65, v65, v23
    v_mul_f32 v66, v66, v23
    v_mul_f32 v67, v67, v23
    v_mul_f32 v68, v68, v23
    v_mul_f32 v69, v69, v23
    v_mul_f32 v70, v70, v23
    v_mul_f32 v71, v71, v23
    v_mul_f32 v72, v72, v23
    v_mul_f32 v73, v73, v23
    v_mul_f32 v74, v74, v23
    v_mul_f32 v75, v75, v23
    v_mul_f32 v76, v76, v23
    v_mul_f32 v77, v77, v23
    v_mul_f32 v78, v78, v23
    v_mul_f32 v79, v79, v23
    v_mul_f32 v80, v80, v23
    v_mul_f32 v81, v81, v23
    v_mul_f32 v82, v82, v23
    v_mul_f32 v83, v83, v23
    v_mul_f32 v84, v84, v23
    v_mul_f32 v85, v85, v23
    v_mul_f32 v86, v86, v23
    v_mul_f32 v87, v87, v23
    v_mul_f32 v88, v88, v23
    v_mul_f32 v89, v89, v23
    v_mul_f32 v90, v90, v23
    v_mul_f32 v91, v91, v23
    v_mul_f32 v92, v92, v23
    v_mul_f32 v93, v93, v23
    v_mul_f32 v94, v94, v23
    v_mul_f32 v95, v95, v23
    v_mul_f32 v96, v96, v23
    v_mul_f32 v97, v97, v23
    v_mul_f32 v98, v98, v23
    v_mul_f32 v99, v99, v23
    v_mul_f32 v100, v100, v23
    v_mul_f32 v101, v101, v23
    v_mul_f32 v102, v102, v23
    v_mul_f32 v103, v103, v23
    v_mul_f32 v104, v104, v23
    v_mul_f32 v105, v105, v23
    v_mul_f32 v106, v106, v23
    v_mul_f32 v107, v107, v23
    v_mul_f32 v108, v108, v23
    v_mul_f32 v109, v109, v23
    v_mul_f32 v110, v110, v23
    v_mul_f32 v111, v111, v23
    v_mul_f32 v112, v112, v23
    v_mul_f32 v113, v113, v23
    v_mul_f32 v114, v114, v23
    v_mul_f32 v115, v115, v23
    v_mul_f32 v116, v116, v23
    v_mul_f32 v117, v117, v23
    v_mul_f32 v118, v118, v23
    v_mul_f32 v119, v119, v23
    v_mul_f32 v120, v120, v23
    v_mul_f32 v121, v121, v23
    v_mul_f32 v122, v122, v23
    v_mul_f32 v123, v123, v23
    v_mul_f32 v124, v124, v23
    v_mul_f32 v125, v125, v23
    v_mul_f32 v126, v126, v23
    v_mul_f32 v127, v127, v23
    s_nop 0
    s_waitcnt lgkmcnt(14)
    v_mfma_f32_32x32x16_bf16 v[64:79], v[184:187], v[144:147], v[64:79]
    s_waitcnt lgkmcnt(12)
    v_mfma_f32_32x32x16_bf16 v[80:95], v[188:191], v[144:147], v[80:95]
    s_waitcnt lgkmcnt(10)
    v_mfma_f32_32x32x16_bf16 v[96:111], v[192:195], v[144:147], v[96:111]
    s_waitcnt lgkmcnt(8)
    v_mfma_f32_32x32x16_bf16 v[112:127], v[196:199], v[144:147], v[112:127]
    s_waitcnt lgkmcnt(6)
    v_mfma_f32_32x32x16_bf16 v[64:79], v[200:203], v[148:151], v[64:79]
    s_waitcnt lgkmcnt(4)
    v_mfma_f32_32x32x16_bf16 v[80:95], v[204:207], v[148:151], v[80:95]
    s_waitcnt lgkmcnt(2)
    v_mfma_f32_32x32x16_bf16 v[96:111], v[208:211], v[148:151], v[96:111]
    s_waitcnt lgkmcnt(0)
    v_mfma_f32_32x32x16_bf16 v[112:127], v[212:215], v[148:151], v[112:127]
L_nc2:
    s_and_b32 s54, s54, 255
    s_add_u32 s54, s54, s53
    s_lshr_b32 s87, s54, 8
    s_cmp_gt_u32 s87, 8
    s_cbranch_scc1 L_wt_41
    s_cmp_gt_u32 s87, 5
    s_cbranch_scc1 L_wt_42
    s_cmp_gt_u32 s87, 3
    s_cbranch_scc1 L_wt_43
    s_cmp_gt_u32 s87, 2
    s_cbranch_scc1 L_win3_29
    s_branch L_win2_28
L_wt_43:
    s_cmp_gt_u32 s87, 4
    s_cbranch_scc1 L_win5_31
    s_branch L_win4_30
L_wt_42:
    s_cmp_gt_u32 s87, 7
    s_cbranch_scc1 L_win8_34
    s_cmp_gt_u32 s87, 6
    s_cbranch_scc1 L_win7_33
    s_branch L_win6_32
L_wt_41:
    s_cmp_gt_u32 s87, 11
    s_cbranch_scc1 L_wt_48
    s_cmp_gt_u32 s87, 10
    s_cbranch_scc1 L_win11_37
    s_cmp_gt_u32 s87, 9
    s_cbranch_scc1 L_win10_36
    s_branch L_win9_35
L_wt_48:
    s_cmp_gt_u32 s87, 13
    s_cbranch_scc1 L_win14_40
    s_cmp_gt_u32 s87, 12
    s_cbranch_scc1 L_win13_39
    s_branch L_win12_38
L_win2_28:
    s_add_u32 m0, s80, 8192
    s_waitcnt vmcnt(1)
    buffer_load_dwordx4 v18, s[8:11], s70 offen nt lds
    s_waitcnt vmcnt(1)
    buffer_load_dwordx4 v19, s[8:11], s70 offen offset:1024 nt lds
    s_waitcnt vmcnt(1)
    buffer_load_dwordx4 v20, s[8:11], s70 offen offset:2048 nt lds
    s_waitcnt vmcnt(1)
    buffer_load_dwordx4 v21, s[8:11], s70 offen offset:3072 nt lds
    s_add_u32 m0, s80, 12288
    s_waitcnt vmcnt(1)
    buffer_load_dwordx4 v18, s[8:11], s71 offen nt lds
    s_waitcnt vmcnt(1)
    buffer_load_dwordx4 v19, s[8:11], s71 offen offset:1024 nt lds
    s_waitcnt vmcnt(1)
    buffer_load_dwordx4 v20, s[8:11], s71 offen offset:2048 nt lds
    s_waitcnt vmcnt(1)
    buffer_load_dwordx4 v21, s[8:11], s71 offen offset:3072 nt lds
    s_branch L_win_done_27
L_win3_29:
    s_add_u32 m0, s80, 8192
    s_waitcnt vmcnt(2)
    buffer_load_dwordx4 v18, s[8:11], s70 offen nt lds
    s_waitcnt vmcnt(2)
    buffer_load_dwordx4 v19, s[8:11], s70 offen offset:1024 nt lds
    s_waitcnt vmcnt(2)
    buffer_load_dwordx4 v20, s[8:11], s70 offen offset:2048 nt lds
    s_waitcnt vmcnt(2)
    buffer_load_dwordx4 v21, s[8:11], s70 offen offset:3072 nt lds
    s_add_u32 m0, s80, 12288
    s_waitcnt vmcnt(2)
    buffer_load_dwordx4 v18, s[8:11], s71 offen nt lds
    s_waitcnt vmcnt(2)
    buffer_load_dwordx4 v19, s[8:11], s71 offen offset:1024 nt lds
    s_waitcnt vmcnt(2)
    buffer_load_dwordx4 v20, s[8:11], s71 offen offset:2048 nt lds
    s_waitcnt vmcnt(2)
    buffer_load_dwordx4 v21, s[8:11], s71 offen offset:3072 nt lds
    s_branch L_win_done_27
L_win4_30:
    s_add_u32 m0, s80, 8192
    s_waitcnt vmcnt(3)
    buffer_load_dwordx4 v18, s[8:11], s70 offen nt lds
    s_waitcnt vmcnt(3)
    buffer_load_dwordx4 v19, s[8:11], s70 offen offset:1024 nt lds
    s_waitcnt vmcnt(3)
    buffer_load_dwordx4 v20, s[8:11], s70 offen offset:2048 nt lds
    s_waitcnt vmcnt(3)
    buffer_load_dwordx4 v21, s[8:11], s70 offen offset:3072 nt lds
    s_add_u32 m0, s80, 12288
    s_waitcnt vmcnt(3)
    buffer_load_dwordx4 v18, s[8:11], s71 offen nt lds
    s_waitcnt vmcnt(3)
    buffer_load_dwordx4 v19, s[8:11], s71 offen offset:1024 nt lds
    s_waitcnt vmcnt(3)
    buffer_load_dwordx4 v20, s[8:11], s71 offen offset:2048 nt lds
    s_waitcnt vmcnt(3)
    buffer_load_dwordx4 v21, s[8:11], s71 offen offset:3072 nt lds
    s_branch L_win_done_27
L_win5_31:
    s_add_u32 m0, s80, 8192
    s_waitcnt vmcnt(4)
    buffer_load_dwordx4 v18, s[8:11], s70 offen nt lds
    s_waitcnt vmcnt(4)
    buffer_load_dwordx4 v19, s[8:11], s70 offen offset:1024 nt lds
    s_waitcnt vmcnt(4)
    buffer_load_dwordx4 v20, s[8:11], s70 offen offset:2048 nt lds
    s_waitcnt vmcnt(4)
    buffer_load_dwordx4 v21, s[8:11], s70 offen offset:3072 nt lds
    s_add_u32 m0, s80, 12288
    s_waitcnt vmcnt(4)
    buffer_load_dwordx4 v18, s[8:11], s71 offen nt lds
    s_waitcnt vmcnt(4)
    buffer_load_dwordx4 v19, s[8:11], s71 offen offset:1024 nt lds
    s_waitcnt vmcnt(4)
    buffer_load_dwordx4 v20, s[8:11], s71 offen offset:2048 nt lds
    s_waitcnt vmcnt(4)
    buffer_load_dwordx4 v21, s[8:11], s71 offen offset:3072 nt lds
    s_branch L_win_done_27
L_win6_32:
    s_add_u32 m0, s80, 8192
    s_waitcnt vmcnt(5)
    buffer_load_dwordx4 v18, s[8:11], s70 offen nt lds
    s_waitcnt vmcnt(5)
    buffer_load_dwordx4 v19, s[8:11], s70 offen offset:1024 nt lds
    s_waitcnt vmcnt(5)
    buffer_load_dwordx4 v20, s[8:11], s70 offen offset:2048 nt lds
    s_waitcnt vmcnt(5)
    buffer_load_dwordx4 v21, s[8:11], s70 offen offset:3072 nt lds
    s_add_u32 m0, s80, 12288
    s_waitcnt vmcnt(5)
    buffer_load_dwordx4 v18, s[8:11], s71 offen nt lds
    s_waitcnt vmcnt(5)
    buffer_load_dwordx4 v19, s[8:11], s71 offen offset:1024 nt lds
    s_waitcnt vmcnt(5)
    buffer_load_dwordx4 v20, s[8:11], s71 offen offset:2048 nt lds
    s_waitcnt vmcnt(5)
    buffer_load_dwordx4 v21, s[8:11], s71 offen offset:3072 nt lds
    s_branch L_win_done_27
L_win7_33:
    s_add_u32 m0, s80, 8192
    s_waitcnt vmcnt(6)
    buffer_load_dwordx4 v18, s[8:11], s70 offen nt lds
    s_waitcnt vmcnt(6)
    buffer_load_dwordx4 v19, s[8:11], s70 offen offset:1024 nt lds
    s_waitcnt vmcnt(6)
    buffer_load_dwordx4 v20, s[8:11], s70 offen offset:2048 nt lds
    s_waitcnt vmcnt(6)
    buffer_load_dwordx4 v21, s[8:11], s70 offen offset:3072 nt lds
    s_add_u32 m0, s80, 12288
    s_waitcnt vmcnt(6)
    buffer_load_dwordx4 v18, s[8:11], s71 offen nt lds
    s_waitcnt vmcnt(6)
    buffer_load_dwordx4 v19, s[8:11], s71 offen offset:1024 nt lds
    s_waitcnt vmcnt(6)
    buffer_load_dwordx4 v20, s[8:11], s71 offen offset:2048 nt lds
    s_waitcnt vmcnt(6)
    buffer_load_dwordx4 v21, s[8:11], s71 offen offset:3072 nt lds
    s_branch L_win_done_27
L_win8_34:
    s_add_u32 m0, s80, 8192
    s_waitcnt vmcnt(7)
    buffer_load_dwordx4 v18, s[8:11], s70 offen nt lds
    s_waitcnt vmcnt(7)
    buffer_load_dwordx4 v19, s[8:11], s70 offen offset:1024 nt lds
    s_waitcnt vmcnt(7)
    buffer_load_dwordx4 v20, s[8:11], s70 offen offset:2048 nt lds
    s_waitcnt vmcnt(7)
    buffer_load_dwordx4 v21, s[8:11], s70 offen offset:3072 nt lds
    s_add_u32 m0, s80, 12288
    s_waitcnt vmcnt(7)
    buffer_load_dwordx4 v18, s[8:11], s71 offen nt lds
    s_waitcnt vmcnt(7)
    buffer_load_dwordx4 v19, s[8:11], s71 offen offset:1024 nt lds
    s_waitcnt vmcnt(7)
    buffer_load_dwordx4 v20, s[8:11], s71 offen offset:2048 nt lds
    s_waitcnt vmcnt(7)
    buffer_load_dwordx4 v21, s[8:11], s71 offen offset:3072 nt lds
    s_branch L_win_done_27
L_win9_35:
    s_add_u32 m0, s80, 8192
    s_waitcnt vmcnt(8)
    buffer_load_dwordx4 v18, s[8:11], s70 offen nt lds
    s_waitcnt vmcnt(8)
    buffer_load_dwordx4 v19, s[8:11], s70 offen offset:1024 nt lds
    s_waitcnt vmcnt(8)
    buffer_load_dwordx4 v20, s[8:11], s70 offen offset:2048 nt lds
    s_waitcnt vmcnt(8)
    buffer_load_dwordx4 v21, s[8:11], s70 offen offset:3072 nt lds
    s_add_u32 m0, s80, 12288
    s_waitcnt vmcnt(8)
    buffer_load_dwordx4 v18, s[8:11], s71 offen nt lds
    s_waitcnt vmcnt(8)
    buffer_load_dwordx4 v19, s[8:11], s71 offen offset:1024 nt lds
    s_waitcnt vmcnt(8)
    buffer_load_dwordx4 v20, s[8:11], s71 offen offset:2048 nt lds
    s_waitcnt vmcnt(8)
    buffer_load_dwordx4 v21, s[8:11], s71 offen offset:3072 nt lds
    s_branch L_win_done_27
L_win10_36:
    s_add_u32 m0, s80, 8192
    s_waitcnt vmcnt(9)
    buffer_load_dwordx4 v18, s[8:11], s70 offen nt lds
    s_waitcnt vmcnt(9)
    buffer_load_dwordx4 v19, s[8:11], s70 offen offset:1024 nt lds
    s_waitcnt vmcnt(9)
    buffer_load_dwordx4 v20, s[8:11], s70 offen offset:2048 nt lds
    s_waitcnt vmcnt(9)
    buffer_load_dwordx4 v21, s[8:11], s70 offen offset:3072 nt lds
    s_add_u32 m0, s80, 12288
    s_waitcnt vmcnt(9)
    buffer_load_dwordx4 v18, s[8:11], s71 offen nt lds
    s_waitcnt vmcnt(9)
    buffer_load_dwordx4 v19, s[8:11], s71 offen offset:1024 nt lds
    s_waitcnt vmcnt(9)
    buffer_load_dwordx4 v20, s[8:11], s71 offen offset:2048 nt lds
    s_waitcnt vmcnt(9)
    buffer_load_dwordx4 v21, s[8:11], s71 offen offset:3072 nt lds
    s_branch L_win_done_27
L_win11_37:
    s_add_u32 m0, s80, 8192
    s_waitcnt vmcnt(10)
    buffer_load_dwordx4 v18, s[8:11], s70 offen nt lds
    s_waitcnt vmcnt(10)
    buffer_load_dwordx4 v19, s[8:11], s70 offen offset:1024 nt lds
    s_waitcnt vmcnt(10)
    buffer_load_dwordx4 v20, s[8:11], s70 offen offset:2048 nt lds
    s_waitcnt vmcnt(10)
    buffer_load_dwordx4 v21, s[8:11], s70 offen offset:3072 nt lds
    s_add_u32 m0, s80, 12288
    s_waitcnt vmcnt(10)
    buffer_load_dwordx4 v18, s[8:11], s71 offen nt lds
    s_waitcnt vmcnt(10)
    buffer_load_dwordx4 v19, s[8:11], s71 offen offset:1024 nt lds
    s_waitcnt vmcnt(10)
    buffer_load_dwordx4 v20, s[8:11], s71 offen offset:2048 nt lds
    s_waitcnt vmcnt(10)
    buffer_load_dwordx4 v21, s[8:11], s71 offen offset:3072 nt lds
    s_branch L_win_done_27
L_win12_38:
    s_add_u32 m0, s80, 8192
    s_waitcnt vmcnt(11)
    buffer_load_dwordx4 v18, s[8:11], s70 offen nt lds
    s_waitcnt vmcnt(11)
    buffer_load_dwordx4 v19, s[8:11], s70 offen offset:1024 nt lds
    s_waitcnt vmcnt(11)
    buffer_load_dwordx4 v20, s[8:11], s70 offen offset:2048 nt lds
    s_waitcnt vmcnt(11)
    buffer_load_dwordx4 v21, s[8:11], s70 offen offset:3072 nt lds
    s_add_u32 m0, s80, 12288
    s_waitcnt vmcnt(11)
    buffer_load_dwordx4 v18, s[8:11], s71 offen nt lds
    s_waitcnt vmcnt(11)
    buffer_load_dwordx4 v19, s[8:11], s71 offen offset:1024 nt lds
    s_waitcnt vmcnt(11)
    buffer_load_dwordx4 v20, s[8:11], s71 offen offset:2048 nt lds
    s_waitcnt vmcnt(11)
    buffer_load_dwordx4 v21, s[8:11], s71 offen offset:3072 nt lds
    s_branch L_win_done_27
L_win13_39:
    s_add_u32 m0, s80, 8192
    s_waitcnt vmcnt(12)
    buffer_load_dwordx4 v18, s[8:11], s70 offen nt lds
    s_waitcnt vmcnt(12)
    buffer_load_dwordx4 v19, s[8:11], s70 offen offset:1024 nt lds
    s_waitcnt vmcnt(12)
    buffer_load_dwordx4 v20, s[8:11], s70 offen offset:2048 nt lds
    s_waitcnt vmcnt(12)
    buffer_load_dwordx4 v21, s[8:11], s70 offen offset:3072 nt lds
    s_add_u32 m0, s80, 12288
    s_waitcnt vmcnt(12)
    buffer_load_dwordx4 v18, s[8:11], s71 offen nt lds
    s_waitcnt vmcnt(12)
    buffer_load_dwordx4 v19, s[8:11], s71 offen offset:1024 nt lds
    s_waitcnt vmcnt(12)
    buffer_load_dwordx4 v20, s[8:11], s71 offen offset:2048 nt lds
    s_waitcnt vmcnt(12)
    buffer_load_dwordx4 v21, s[8:11], s71 offen offset:3072 nt lds
    s_branch L_win_done_27
L_win14_40:
    s_add_u32 m0, s80, 8192
    s_nop 0
    buffer_load_dwordx4 v18, s[8:11], s70 offen nt lds
    buffer_load_dwordx4 v19, s[8:11], s70 offen offset:1024 nt lds
    buffer_load_dwordx4 v20, s[8:11], s70 offen offset:2048 nt lds
    buffer_load_dwordx4 v21, s[8:11], s70 offen offset:3072 nt lds
    s_add_u32 m0, s80, 12288
    s_nop 0
    buffer_load_dwordx4 v18, s[8:11], s71 offen nt lds
    buffer_load_dwordx4 v19, s[8:11], s71 offen offset:1024 nt lds
    buffer_load_dwordx4 v20, s[8:11], s71 offen offset:2048 nt lds
    buffer_load_dwordx4 v21, s[8:11], s71 offen offset:3072 nt lds
L_win_done_27:
    s_xor_b32 s80, s80, 0x4000
    v_xor_b32 v2, 0x4000, v2
    v_xor_b32 v3, 0x4000, v3
    v_xor_b32 v4, 0x4000, v4
    v_xor_b32 v5, 0x4000, v5
    v_xor_b32 v6, 0x4000, v6
    v_xor_b32 v7, 0x4000, v7
    v_xor_b32 v8, 0x4000, v8
    v_xor_b32 v9, 0x4000, v9
    v_xor_b32 v10, 0x4000, v10
    v_xor_b32 v11, 0x4000, v11
    v_xor_b32 v12, 0x4000, v12
    v_xor_b32 v13, 0x4000, v13
    s_cmp_lg_u32 s82, 0
    s_cbranch_scc1 L_hk
L_hk_ret:
    s_add_u32 s85, s85, 1
    s_add_u32 s72, s72, 4
    s_cmp_eq_u32 s77, 2
    s_cselect_b32 s72, s56, s72
    s_cmp_lt_u32 s72, s73
    s_cbranch_scc1 L_tile
L_seg_end:
    s_cmp_eq_u32 s77, 1
    s_cbranch_scc1 L_chain
    s_cmp_eq_u32 s77, 2
    s_cbranch_scc1 L_final
    s_cmp_eq_u32 s59, 0
    s_cbranch_scc1 L_next_seg
    v_accvgpr_write_b32 a64, v64
    v_accvgpr_write_b32 a65, v65
    v_accvgpr_write_b32 a66, v66
    v_accvgpr_write_b32 a67, v67
    v_accvgpr_write_b32 a68, v68
    v_accvgpr_write_b32 a69, v69
    v_accvgpr_write_b32 a70, v70
    v_accvgpr_write_b32 a71, v71
    v_accvgpr_write_b32 a72, v72
    v_accvgpr_write_b32 a73, v73
    v_accvgpr_write_b32 a74, v74
    v_accvgpr_write_b32 a75, v75
    v_accvgpr_write_b32 a76, v76
    v_accvgpr_write_b32 a77, v77
    v_accvgpr_write_b32 a78, v78
    v_accvgpr_write_b32 a79, v79
    v_accvgpr_write_b32 a80, v80
    v_accvgpr_write_b32 a81, v81
    v_accvgpr_write_b32 a82, v82
    v_accvgpr_write_b32 a83, v83
    v_accvgpr_write_b32 a84, v84
    v_accvgpr_write_b32 a85, v85
    v_accvgpr_write_b32 a86, v86
    v_accvgpr_write_b32 a87, v87
    v_accvgpr_write_b32 a88, v88
    v_accvgpr_write_b32 a89, v89
    v_accvgpr_write_b32 a90, v90
    v_accvgpr_write_b32 a91, v91
    v_accvgpr_write_b32 a92, v92
    v_accvgpr_write_b32 a93, v93
    v_accvgpr_write_b32 a94, v94
    v_accvgpr_write_b32 a95, v95
    v_accvgpr_write_b32 a96, v96
    v_accvgpr_write_b32 a97, v97
    v_accvgpr_write_b32 a98, v98
    v_accvgpr_write_b32 a99, v99
    v_accvgpr_write_b32 a100, v100
    v_accvgpr_write_b32 a101, v101
    v_accvgpr_write_b32 a102, v102
    v_accvgpr_write_b32 a103, v103
    v_accvgpr_write_b32 a104, v104
    v_accvgpr_write_b32 a105, v105
    v_accvgpr_write_b32 a106, v106
    v_accvgpr_write_b32 a107, v107
    v_accvgpr_write_b32 a108, v108
    v_accvgpr_write_b32 a109, v109
    v_accvgpr_write_b32 a110, v110
    v_accvgpr_write_b32 a111, v111
    v_accvgpr_write_b32 a112, v112
    v_accvgpr_write_b32 a113, v113
    v_accvgpr_write_b32 a114, v114
    v_accvgpr_write_b32 a115, v115
    v_accvgpr_write_b32 a116, v116
    v_accvgpr_write_b32 a117, v117
    v_accvgpr_write_b32 a118, v118
    v_accvgpr_write_b32 a119, v119
    v_accvgpr_write_b32 a120, v120
    v_accvgpr_write_b32 a121, v121
    v_accvgpr_write_b32 a122, v122
    v_accvgpr_write_b32 a123, v123
    v_accvgpr_write_b32 a124, v124
    v_accvgpr_write_b32 a125, v125
    v_accvgpr_write_b32 a126, v126
    v_accvgpr_write_b32 a127, v127
    v_accvgpr_write_b32 a128, v24
    v_accvgpr_write_b32 a129, v25
L_next_seg:
    s_sub_u32 s89, s72, s73
    s_cmp_lg_u64 s[44:45], 0
    s_cbranch_scc1 L_nb0_54
    s_cmp_lg_u64 s[46:47], 0
    s_cbranch_scc1 L_nb1_55
    s_cmp_lg_u64 s[48:49], 0
    s_cbranch_scc1 L_nb2_56
    s_cmp_lg_u64 s[50:51], 0
    s_cbranch_scc1 L_nb3_57
    s_branch L_cs_none
L_nb0_54:
    s_ff1_i32_b64 s75, s[44:45]
    s_bitset0_b64 s[44:45], s75
    v_readlane_b32 s88, v52, s75
    s_add_u32 s75, s75, 0
    s_branch L_nb_done_53
L_nb1_55:
    s_ff1_i32_b64 s75, s[46:47]
    s_bitset0_b64 s[46:47], s75
    v_readlane_b32 s88, v53, s75
    s_add_u32 s75, s75, 64
    s_branch L_nb_done_53
L_nb2_56:
    s_ff1_i32_b64 s75, s[48:49]
    s_bitset0_b64 s[48:49], s75
    v_readlane_b32 s88, v54, s75
    s_add_u32 s75, s75, 128
    s_branch L_nb_done_53
L_nb3_57:
    s_ff1_i32_b64 s75, s[50:51]
    s_bitset0_b64 s[50:51], s75
    v_readlane_b32 s88, v55, s75
    s_add_u32 s75, s75, 192
L_nb_done_53:
    s_mov_b32 s77, 1
    s_and_b32 s74, s88, 255
    s_lshr_b32 s73, s88, 8
    s_add_u32 s72, s74, s89
    s_cmp_lt_u32 s72, s73
    s_cbranch_scc1 L_seg_mine
    s_add_u32 s20, s20, 1
    s_branch L_next_seg
L_seg_mine:
    s_and_b32 s87, s75, 15
    v_readlane_b32 s76, v57, s87
    s_mov_b32 s78, 1
    v_mov_b32 v64, 0
    v_mov_b32 v65, 0
    v_mov_b32 v66, 0
    v_mov_b32 v67, 0
    v_mov_b32 v68, 0
    v_mov_b32 v69, 0
    v_mov_b32 v70, 0
    v_mov_b32 v71, 0
    v_mov_b32 v72, 0
    v_mov_b32 v73, 0
    v_mov_b32 v74, 0
    v_mov_b32 v75, 0
    v_mov_b32 v76, 0
    v_mov_b32 v77, 0
    v_mov_b32 v78, 0
    v_mov_b32 v79, 0
    v_mov_b32 v80, 0
    v_mov_b32 v81, 0
    v_mov_b32 v82, 0
    v_mov_b32 v83, 0
    v_mov_b32 v84, 0
    v_mov_b32 v85, 0
    v_mov_b32 v86, 0
    v_mov_b32 v87, 0
    v_mov_b32 v88, 0
    v_mov_b32 v89, 0
    v_mov_b32 v90, 0
    v_mov_b32 v91, 0
    v_mov_b32 v92, 0
    v_mov_b32 v93, 0
    v_mov_b32 v94, 0
    v_mov_b32 v95, 0
    v_mov_b32 v96, 0
    v_mov_b32 v97, 0
    v_mov_b32 v98, 0
    v_mov_b32 v99, 0
    v_mov_b32 v100, 0
    v_mov_b32 v101, 0
    v_mov_b32 v102, 0
    v_mov_b32 v103, 0
    v_mov_b32 v104, 0
    v_mov_b32 v105, 0
    v_mov_b32 v106, 0
    v_mov_b32 v107, 0
    v_mov_b32 v108, 0
    v_mov_b32 v109, 0
    v_mov_b32 v110, 0
    v_mov_b32 v111, 0
    v_mov_b32 v112, 0
    v_mov_b32 v113, 0
    v_mov_b32 v114, 0
    v_mov_b32 v115, 0
    v_mov_b32 v116, 0
    v_mov_b32 v117, 0
    v_mov_b32 v118, 0
    v_mov_b32 v119, 0
    v_mov_b32 v120, 0
    v_mov_b32 v121, 0
    v_mov_b32 v122, 0
    v_mov_b32 v123, 0
    v_mov_b32 v124, 0
    v_mov_b32 v125, 0
    v_mov_b32 v126, 0
    v_mov_b32 v127, 0
    v_mov_b32 v24, 0xff61b1e6
    v_mov_b32 v25, 0
    s_branch L_tile
L_cs_none:
    s_mov_b32 s77, 2
    s_mov_b32 s72, s56
    s_mov_b32 s73, s57
    s_mov_b32 s75, s55
    s_mov_b32 s74, 0
    s_mov_b32 s76, s58
    s_mov_b32 s78, s59
    s_cmp_eq_u32 s59, 0
    s_cbranch_scc1 L_seg_go
    v_accvgpr_read_b32 v64, a64
    v_accvgpr_read_b32 v65, a65
    v_accvgpr_read_b32 v66, a66
    v_accvgpr_read_b32 v67, a67
    v_accvgpr_read_b32 v68, a68
    v_accvgpr_read_b32 v69, a69
    v_accvgpr_read_b32 v70, a70
    v_accvgpr_read_b32 v71, a71
    v_accvgpr_read_b32 v72, a72
    v_accvgpr_read_b32 v73, a73
    v_accvgpr_read_b32 v74, a74
    v_accvgpr_read_b32 v75, a75
    v_accvgpr_read_b32 v76, a76
    v_accvgpr_read_b32 v77, a77
    v_accvgpr_read_b32 v78, a78
    v_accvgpr_read_b32 v79, a79
    v_accvgpr_read_b32 v80, a80
    v_accvgpr_read_b32 v81, a81
    v_accvgpr_read_b32 v82, a82
    v_accvgpr_read_b32 v83, a83
    v_accvgpr_read_b32 v84, a84
    v_accvgpr_read_b32 v85, a85
    v_accvgpr_read_b32 v86, a86
    v_accvgpr_read_b32 v87, a87
    v_accvgpr_read_b32 v88, a88
    v_accvgpr_read_b32 v89, a89
    v_accvgpr_read_b32 v90, a90
    v_accvgpr_read_b32 v91, a91
    v_accvgpr_read_b32 v92, a92
    v_accvgpr_read_b32 v93, a93
    v_accvgpr_read_b32 v94, a94
    v_accvgpr_read_b32 v95, a95
    v_accvgpr_read_b32 v96, a96
    v_accvgpr_read_b32 v97, a97
    v_accvgpr_read_b32 v98, a98
    v_accvgpr_read_b32 v99, a99
    v_accvgpr_read_b32 v100, a100
    v_accvgpr_read_b32 v101, a101
    v_accvgpr_read_b32 v102, a102
    v_accvgpr_read_b32 v103, a103
    v_accvgpr_read_b32 v104, a104
    v_accvgpr_read_b32 v105, a105
    v_accvgpr_read_b32 v106, a106
    v_accvgpr_read_b32 v107, a107
    v_accvgpr_read_b32 v108, a108
    v_accvgpr_read_b32 v109, a109
    v_accvgpr_read_b32 v110, a110
    v_accvgpr_read_b32 v111, a111
    v_accvgpr_read_b32 v112, a112
    v_accvgpr_read_b32 v113, a113
    v_accvgpr_read_b32 v114, a114
    v_accvgpr_read_b32 v115, a115
    v_accvgpr_read_b32 v116, a116
    v_accvgpr_read_b32 v117, a117
    v_accvgpr_read_b32 v118, a118
    v_accvgpr_read_b32 v119, a119
    v_accvgpr_read_b32 v120, a120
    v_accvgpr_read_b32 v121, a121
    v_accvgpr_read_b32 v122, a122
    v_accvgpr_read_b32 v123, a123
    v_accvgpr_read_b32 v124, a124
    v_accvgpr_read_b32 v125, a125
    v_accvgpr_read_b32 v126, a126
    v_accvgpr_read_b32 v127, a127
    v_accvgpr_read_b32 v24, a128
    v_accvgpr_read_b32 v25, a129
L_seg_go:
    s_cmp_lt_u32 s72, s73
    s_cbranch_scc1 L_tile
L_final:
    s_mov_b32 s93, 1
    s_branch L_hk_flush
L_flush_ret1:
    v_mov_b32 v27, v25
    s_nop 1
    v_permlane32_swap_b32 v25, v27
    s_nop 1
    v_add_f32 v25, v25, v27
    s_waitcnt vmcnt(0)
    s_lshl_b32 s87, s52, 15
    v_add_u32 v26, s87, v60
    v_add_u32 v27, s87, v59
    ds_write_b64 v27, v[24:25] offset:12288
    ds_write_b128 v26, v[80:83]
    ds_write_b128 v26, v[84:87] offset:1024
    ds_write_b128 v26, v[88:91] offset:2048
    ds_write_b128 v26, v[92:95] offset:3072
    ds_write_b128 v26, v[96:99] offset:4096
    ds_write_b128 v26, v[100:103] offset:5120
    ds_write_b128 v26, v[104:107] offset:6144
    ds_write_b128 v26, v[108:111] offset:7168
    ds_write_b128 v26, v[112:115] offset:8192
    ds_write_b128 v26, v[116:119] offset:9216
    ds_write_b128 v26, v[120:123] offset:10240
    ds_write_b128 v26, v[124:127] offset:11264
    s_lshl_b32 s87, s52, 2
    v_add_u32 v28, s87, v63
    v_mov_b32 v29, s23
    ds_write_b32 v28, v29 offset:16
    s_cmp_lg_u32 s52, 0
    s_cbranch_scc1 L_nopoll
    s_cmp_eq_u32 s67, 0
    s_cbranch_scc1 L_nopoll
    s_cmp_lg_u32 s23, 0
    s_cbranch_scc1 L_nopoll
    s_and_b32 s87, s55, 63
    s_lshr_b32 s88, s55, 6
    v_readlane_b32 s89, v40, s87
    v_readlane_b32 s3, v41, s87
    s_cmp_eq_u32 s88, 1
    s_cselect_b32 s89, s3, s89
    v_readlane_b32 s3, v42, s87
    s_cmp_eq_u32 s88, 2
    s_cselect_b32 s89, s3, s89
    v_readlane_b32 s3, v43, s87
    s_cmp_eq_u32 s88, 3
    s_cselect_b32 s89, s3, s89
    v_readlane_b32 s90, v48, s87
    v_readlane_b32 s3, v49, s87
    s_cmp_eq_u32 s88, 1
    s_cselect_b32 s90, s3, s90
    v_readlane_b32 s3, v50, s87
    s_cmp_eq_u32 s88, 2
    s_cselect_b32 s90, s3, s90
    v_readlane_b32 s3, v51, s87
    s_cmp_eq_u32 s88, 3
    s_cselect_b32 s90, s3, s90
    v_readlane_b32 s91, v44, s87
    v_readlane_b32 s3, v45, s87
    s_cmp_eq_u32 s88, 1
    s_cselect_b32 s91, s3, s91
    v_readlane_b32 s3, v46, s87
    s_cmp_eq_u32 s88, 2
    s_cselect_b32 s91, s3, s91
    v_readlane_b32 s3, v47, s87
    s_cmp_eq_u32 s88, 3
    s_cselect_b32 s91, s3, s91
    v_readlane_b32 s92, v56, s87
    s_sub_u32 s92, s92, s91
    s_lshr_b32 s3, s92, 1
    s_min_u32 s3, s3, 16
    v_mov_b32 v28, s92
    s_sub_u32 s3, s92, s3
    s_sub_u32 s91, s92, 1
    s_ashr_i32 s91, s91, 1
    s_min_i32 s91, s91, 16
    v_subrev_u32 v29, s89, v32
    v_cvt_f32_i32 v29, v29
    v_mul_f32 v29, s90, v29
    v_ceil_f32 v29, v29
    v_cvt_i32_f32 v29, v29
    v_med3_i32 v29, v29, 0, v28
    v_cmp_lt_i32 vcc, s91, v29
    s_nop 1
    v_cndmask_b32 v27, 0, v29, vcc
    v_cmp_le_i32 vcc, s3, v29
    s_nop 1
    v_cndmask_b32 v29, v27, v28, vcc
    v_subrev_u32 v26, s89, v36
    v_cvt_f32_i32 v26, v26
    v_mul_f32 v26, s90, v26
    v_ceil_f32 v26, v26
    v_cvt_i32_f32 v26, v26
    v_med3_i32 v26, v26, 0, v28
    v_cmp_lt_i32 vcc, s91, v26
    s_nop 1
    v_cndmask_b32 v27, 0, v26, vcc
    v_cmp_le_i32 vcc, s3, v26
    s_nop 1
    v_cndmask_b32 v26, v27, v28, vcc
    v_cmp_gt_i32 s[94:95], v26, v29
    v_subrev_u32 v29, s89, v33
    v_cvt_f32_i32 v29, v29
    v_mul_f32 v29, s90, v29
    v_ceil_f32 v29, v29
    v_cvt_i32_f32 v29, v29
    v_med3_i32 v29, v29, 0, v28
    v_cmp_lt_i32 vcc, s91, v29
    s_nop 1
    v_cndmask_b32 v27, 0, v29, vcc
    v_cmp_le_i32 vcc, s3, v29
    s_nop 1
    v_cndmask_b32 v29, v27, v28, vcc
    v_subrev_u32 v26, s89, v37
    v_cvt_f32_i32 v26, v26
    v_mul_f32 v26, s90, v26
    v_ceil_f32 v26, v26
    v_cvt_i32_f32 v26, v26
    v_med3_i32 v26, v26, 0, v28
    v_cmp_lt_i32 vcc, s91, v26
    s_nop 1
    v_cndmask_b32 v27, 0, v26, vcc
    v_cmp_le_i32 vcc, s3, v26
    s_nop 1
    v_cndmask_b32 v26, v27, v28, vcc
    v_cmp_gt_i32 s[96:97], v26, v29
    v_subrev_u32 v29, s89, v34
    v_cvt_f32_i32 v29, v29
    v_mul_f32 v29, s90, v29
    v_ceil_f32 v29, v29
    v_cvt_i32_f32 v29, v29
    v_med3_i32 v29, v29, 0, v28
    v_cmp_lt_i32 vcc, s91, v29
    s_nop 1
    v_cndmask_b32 v27, 0, v29, vcc
    v_cmp_le_i32 vcc, s3, v29
    s_nop 1
    v_cndmask_b32 v29, v27, v28, vcc
    v_subrev_u32 v26, s89, v38
    v_cvt_f32_i32 v26, v26
    v_mul_f32 v26, s90, v26
    v_ceil_f32 v26, v26
    v_cvt_i32_f32 v26, v26
    v_med3_i32 v26, v26, 0, v28
    v_cmp_lt_i32 vcc, s91, v26
    s_nop 1
    v_cndmask_b32 v27, 0, v26, vcc
    v_cmp_le_i32 vcc, s3, v26
    s_nop 1
    v_cndmask_b32 v26, v27, v28, vcc
    v_cmp_gt_i32 s[98:99], v26, v29
    v_subrev_u32 v29, s89, v35
    v_cvt_f32_i32 v29, v29
    v_mul_f32 v29, s90, v29
    v_ceil_f32 v29, v29
    v_cvt_i32_f32 v29, v29
    v_med3_i32 v29, v29, 0, v28
    v_cmp_lt_i32 vcc, s91, v29
    s_nop 1
    v_cndmask_b32 v27, 0, v29, vcc
    v_cmp_le_i32 vcc, s3, v29
    s_nop 1
    v_cndmask_b32 v29, v27, v28, vcc
    v_subrev_u32 v26, s89, v39
    v_cvt_f32_i32 v26, v26
    v_mul_f32 v26, s90, v26
    v_ceil_f32 v26, v26
    v_cvt_i32_f32 v26, v26
    v_med3_i32 v26, v26, 0, v28
    v_cmp_lt_i32 vcc, s91, v26
    s_nop 1
    v_cndmask_b32 v27, 0, v26, vcc
    v_cmp_le_i32 vcc, s3, v26
    s_nop 1
    v_cndmask_b32 v26, v27, v28, vcc
    v_cmp_gt_i32 s[100:101], v26, v29
    s_nop 1
    v_mov_b32 v28, s55
    v_add_u32 v29, 1, v28
    s_mov_b64 s[88:89], 0
    v_add_u32 v26, 0, v1
    v_cmp_lt_u32 vcc, v28, v26
    v_bfe_u32 v27, v61, 0, 8
    s_nop 0
    v_cndmask_b32 v26, v28, v29, vcc
    v_cmp_lt_u32 vcc, v27, v26
    s_nop 1
    s_and_b64 s[90:91], vcc, s[94:95]
    s_or_b64 s[88:89], s[88:89], s[90:91]
    v_add_u32 v26, 64, v1
    v_cmp_lt_u32 vcc, v28, v26
    v_bfe_u32 v27, v61, 8, 8
    s_nop 0
    v_cndmask_b32 v26, v28, v29, vcc
    v_cmp_lt_u32 vcc, v27, v26
    s_nop 1
    s_and_b64 s[90:91], vcc, s[96:97]
    s_or_b64 s[88:89], s[88:89], s[90:91]
    v_add_u32 v26, 128, v1
    v_cmp_lt_u32 vcc, v28, v26
    v_bfe_u32 v27, v61, 16, 8
    s_nop 0
    v_cndmask_b32 v26, v28, v29, vcc
    v_cmp_lt_u32 vcc, v27, v26
    s_nop 1
    s_and_b64 s[90:91], vcc, s[98:99]
    s_or_b64 s[88:89], s[88:89], s[90:91]
    v_add_u32 v26, 192, v1
    v_cmp_lt_u32 vcc, v28, v26
    v_bfe_u32 v27, v61, 24, 8
    s_nop 0
    v_cndmask_b32 v26, v28, v29, vcc
    v_cmp_lt_u32 vcc, v27, v26
    s_nop 1
    s_and_b64 s[90:91], vcc, s[100:101]
    s_or_b64 s[88:89], s[88:89], s[90:91]
    s_cselect_b32 s87, 0, 1
    v_mov_b32 v29, s87
    ds_write_b32 v63, v29 offset:36
L_nopoll:
    s_waitcnt lgkmcnt(0)
    s_barrier
    s_sub_u32 s87, s52, 1
    s_and_b32 s87, s87, 3
    s_lshl_b32 s87, s87, 15
    v_add_u32 v26, s87, v60
    v_add_u32 v27, s87, v59
    ds_read_b64 v[134:135], v27 offset:12288
    ds_read_b128 v[152:155], v26
    ds_read_b128 v[156:159], v26 offset:1024
    ds_read_b128 v[160:163], v26 offset:2048
    ds_read_b128 v[164:167], v26 offset:3072
    s_sub_u32 s87, s52, 2
    s_and_b32 s87, s87, 3
    s_lshl_b32 s87, s87, 15
    v_add_u32 v26, s87, v60
    v_add_u32 v27, s87, v59
    ds_read_b64 v[136:137], v27 offset:12288
    ds_read_b128 v[168:171], v26 offset:4096
    ds_read_b128 v[172:175], v26 offset:5120
    ds_read_b128 v[176:179], v26 offset:6144
    ds_read_b128 v[180:183], v26 offset:7168
    s_sub_u32 s87, s52, 3
    s_and_b32 s87, s87, 3
    s_lshl_b32 s87, s87, 15
    v_add_u32 v26, s87, v60
    v_add_u32 v27, s87, v59
    ds_read_b64 v[138:139], v27 offset:12288
    ds_read_b128 v[184:187], v26 offset:8192
    ds_read_b128 v[188:191], v26 offset:9216
    ds_read_b128 v[192:195], v26 offset:10240
    ds_read_b128 v[196:199], v26 offset:11264
    s_waitcnt lgkmcnt(4)
    ds_read_b128 v[144:147], v63 offset:16
    ds_read_b32 v148, v63 offset:36
    v_max3_f32 v250, v134, v136, v138
    v_max_f32 v250, v250, v24
    v_sub_f32 v28, v24, v250
    v_sub_f32 v134, v134, v250
    v_sub_f32 v136, v136, v250
    v_sub_f32 v138, v138, v250
    v_exp_f32 v28, v28
    v_exp_f32 v134, v134
    v_exp_f32 v136, v136
    v_exp_f32 v138, v138
    v_mul_f32 v251, v25, v28
    v_fmac_f32 v251, v134, v135
    v_fmac_f32 v251, v136, v137
    v_fmac_f32 v251, v138, v139
    v_mul_f32 v64, v64, v28
    v_mul_f32 v65, v65, v28
    v_mul_f32 v66, v66, v28
    v_mul_f32 v67, v67, v28
    v_mul_f32 v68, v68, v28
    v_mul_f32 v69, v69, v28
    v_mul_f32 v70, v70, v28
    v_mul_f32 v71, v71, v28
    v_mul_f32 v72, v72, v28
    v_mul_f32 v73, v73, v28
    v_mul_f32 v74, v74, v28
    v_mul_f32 v75, v75, v28
    v_mul_f32 v76, v76, v28
    v_mul_f32 v77, v77, v28
    v_mul_f32 v78, v78, v28
    v_mul_f32 v79, v79, v28
    s_waitcnt lgkmcnt(0)
    v_fmac_f32 v64, v152, v134
    v_fmac_f32 v65, v153, v134
    v_fmac_f32 v66, v154, v134
    v_fmac_f32 v67, v155, v134
    v_fmac_f32 v68, v156, v134
    v_fmac_f32 v69, v157, v134
    v_fmac_f32 v70, v158, v134
    v_fmac_f32 v71, v159, v134
    v_fmac_f32 v72, v160, v134
    v_fmac_f32 v73, v161, v134
    v_fmac_f32 v74, v162, v134
    v_fmac_f32 v75, v163, v134
    v_fmac_f32 v76, v164, v134
    v_fmac_f32 v77, v165, v134
    v_fmac_f32 v78, v166, v134
    v_fmac_f32 v79, v167, v134
    v_fmac_f32 v64, v168, v136
    v_fmac_f32 v65, v169, v136
    v_fmac_f32 v66, v170, v136
    v_fmac_f32 v67, v171, v136
    v_fmac_f32 v68, v172, v136
    v_fmac_f32 v69, v173, v136
    v_fmac_f32 v70, v174, v136
    v_fmac_f32 v71, v175, v136
    v_fmac_f32 v72, v176, v136
    v_fmac_f32 v73, v177, v136
    v_fmac_f32 v74, v178, v136
    v_fmac_f32 v75, v179, v136
    v_fmac_f32 v76, v180, v136
    v_fmac_f32 v77, v181, v136
    v_fmac_f32 v78, v182, v136
    v_fmac_f32 v79, v183, v136
    v_fmac_f32 v64, v184, v138
    v_fmac_f32 v65, v185, v138
    v_fmac_f32 v66, v186, v138
    v_fmac_f32 v67, v187, v138
    v_fmac_f32 v68, v188, v138
    v_fmac_f32 v69, v189, v138
    v_fmac_f32 v70, v190, v138
    v_fmac_f32 v71, v191, v138
    v_fmac_f32 v72, v192, v138
    v_fmac_f32 v73, v193, v138
    v_fmac_f32 v74, v194, v138
    v_fmac_f32 v75, v195, v138
    v_fmac_f32 v76, v196, v138
    v_fmac_f32 v77, v197, v138
    v_fmac_f32 v78, v198, v138
    v_fmac_f32 v79, v199, v138
    s_cmp_eq_u32 s67, 0
    s_cbranch_scc1 L_out_direct
    s_mov_b32 s21, 0
    v_readfirstlane_b32 s87, v144
    s_lshr_b32 s87, s87, 1
    s_lshl_b32 s87, s87, 0
    s_or_b32 s21, s21, s87
    v_readfirstlane_b32 s87, v145
    s_lshr_b32 s87, s87, 1
    s_lshl_b32 s87, s87, 1
    s_or_b32 s21, s21, s87
    v_readfirstlane_b32 s87, v146
    s_lshr_b32 s87, s87, 1
    s_lshl_b32 s87, s87, 2
    s_or_b32 s21, s21, s87
    v_readfirstlane_b32 s87, v147
    s_lshr_b32 s87, s87, 1
    s_lshl_b32 s87, s87, 3
    s_or_b32 s21, s21, s87
    s_cmp_eq_u32 s21, 15
    s_cbranch_scc1 L_out_direct
    s_cmp_lg_u32 s21, 0
    s_cbranch_scc1 L_path_a
    v_readfirstlane_b32 s92, v148
    s_cmp_eq_u32 s92, 0
    s_cbranch_scc1 L_own_publish
L_path_a:
    s_and_b32 s87, s55, 63
    s_lshr_b32 s88, s55, 6
    v_readlane_b32 s89, v40, s87
    v_readlane_b32 s3, v41, s87
    s_cmp_eq_u32 s88, 1
    s_cselect_b32 s89, s3, s89
    v_readlane_b32 s3, v42, s87
    s_cmp_eq_u32 s88, 2
    s_cselect_b32 s89, s3, s89
    v_readlane_b32 s3, v43, s87
    s_cmp_eq_u32 s88, 3
    s_cselect_b32 s89, s3, s89
    v_readlane_b32 s90, v48, s87
    v_readlane_b32 s3, v49, s87
    s_cmp_eq_u32 s88, 1
    s_cselect_b32 s90, s3, s90
    v_readlane_b32 s3, v50, s87
    s_cmp_eq_u32 s88, 2
    s_cselect_b32 s90, s3, s90
    v_readlane_b32 s3, v51, s87
    s_cmp_eq_u32 s88, 3
    s_cselect_b32 s90, s3, s90
    v_readlane_b32 s91, v44, s87
    v_readlane_b32 s3, v45, s87
    s_cmp_eq_u32 s88, 1
    s_cselect_b32 s91, s3, s91
    v_readlane_b32 s3, v46, s87
    s_cmp_eq_u32 s88, 2
    s_cselect_b32 s91, s3, s91
    v_readlane_b32 s3, v47, s87
    s_cmp_eq_u32 s88, 3
    s_cselect_b32 s91, s3, s91
    v_readlane_b32 s92, v56, s87
    s_sub_u32 s92, s92, s91
    s_lshr_b32 s3, s92, 1
    s_min_u32 s3, s3, 16
    v_mov_b32 v28, s92
    s_sub_u32 s3, s92, s3
    s_sub_u32 s91, s92, 1
    s_ashr_i32 s91, s91, 1
    s_min_i32 s91, s91, 16
    v_subrev_u32 v29, s89, v32
    v_cvt_f32_i32 v29, v29
    v_mul_f32 v29, s90, v29
    v_ceil_f32 v29, v29
    v_cvt_i32_f32 v29, v29
    v_med3_i32 v29, v29, 0, v28
    v_cmp_lt_i32 vcc, s91, v29
    s_nop 1
    v_cndmask_b32 v27, 0, v29, vcc
    v_cmp_le_i32 vcc, s3, v29
    s_nop 1
    v_cndmask_b32 v29, v27, v28, vcc
    v_subrev_u32 v26, s89, v36
    v_cvt_f32_i32 v26, v26
    v_mul_f32 v26, s90, v26
    v_ceil_f32 v26, v26
    v_cvt_i32_f32 v26, v26
    v_med3_i32 v26, v26, 0, v28
    v_cmp_lt_i32 vcc, s91, v26
    s_nop 1
    v_cndmask_b32 v27, 0, v26, vcc
    v_cmp_le_i32 vcc, s3, v26
    s_nop 1
    v_cndmask_b32 v26, v27, v28, vcc
    v_cmp_gt_i32 s[94:95], v26, v29
    v_subrev_u32 v29, s89, v33
    v_cvt_f32_i32 v29, v29
    v_mul_f32 v29, s90, v29
    v_ceil_f32 v29, v29
    v_cvt_i32_f32 v29, v29
    v_med3_i32 v29, v29, 0, v28
    v_cmp_lt_i32 vcc, s91, v29
    s_nop 1
    v_cndmask_b32 v27, 0, v29, vcc
    v_cmp_le_i32 vcc, s3, v29
    s_nop 1
    v_cndmask_b32 v29, v27, v28, vcc
    v_subrev_u32 v26, s89, v37
    v_cvt_f32_i32 v26, v26
    v_mul_f32 v26, s90, v26
    v_ceil_f32 v26, v26
    v_cvt_i32_f32 v26, v26
    v_med3_i32 v26, v26, 0, v28
    v_cmp_lt_i32 vcc, s91, v26
    s_nop 1
    v_cndmask_b32 v27, 0, v26, vcc
    v_cmp_le_i32 vcc, s3, v26
    s_nop 1
    v_cndmask_b32 v26, v27, v28, vcc
    v_cmp_gt_i32 s[96:97], v26, v29
    v_subrev_u32 v29, s89, v34
    v_cvt_f32_i32 v29, v29
    v_mul_f32 v29, s90, v29
    v_ceil_f32 v29, v29
    v_cvt_i32_f32 v29, v29
    v_med3_i32 v29, v29, 0, v28
    v_cmp_lt_i32 vcc, s91, v29
    s_nop 1
    v_cndmask_b32 v27, 0, v29, vcc
    v_cmp_le_i32 vcc, s3, v29
    s_nop 1
    v_cndmask_b32 v29, v27, v28, vcc
    v_subrev_u32 v26, s89, v38
    v_cvt_f32_i32 v26, v26
    v_mul_f32 v26, s90, v26
    v_ceil_f32 v26, v26
    v_cvt_i32_f32 v26, v26
    v_med3_i32 v26, v26, 0, v28
    v_cmp_lt_i32 vcc, s91, v26
    s_nop 1
    v_cndmask_b32 v27, 0, v26, vcc
    v_cmp_le_i32 vcc, s3, v26
    s_nop 1
    v_cndmask_b32 v26, v27, v28, vcc
    v_cmp_gt_i32 s[98:99], v26, v29
    v_subrev_u32 v29, s89, v35
    v_cvt_f32_i32 v29, v29
    v_mul_f32 v29, s90, v29
    v_ceil_f32 v29, v29
    v_cvt_i32_f32 v29, v29
    v_med3_i32 v29, v29, 0, v28
    v_cmp_lt_i32 vcc, s91, v29
    s_nop 1
    v_cndmask_b32 v27, 0, v29, vcc
    v_cmp_le_i32 vcc, s3, v29
    s_nop 1
    v_cndmask_b32 v29, v27, v28, vcc
    v_subrev_u32 v26, s89, v39
    v_cvt_f32_i32 v26, v26
    v_mul_f32 v26, s90, v26
    v_ceil_f32 v26, v26
    v_cvt_i32_f32 v26, v26
    v_med3_i32 v26, v26, 0, v28
    v_cmp_lt_i32 vcc, s91, v26
    s_nop 1
    v_cndmask_b32 v27, 0, v26, vcc
    v_cmp_le_i32 vcc, s3, v26
    s_nop 1
    v_cndmask_b32 v26, v27, v28, vcc
    v_cmp_gt_i32 s[100:101], v26, v29
    s_nop 1
    s_mov_b32 s22, 0
L_pa_loop:
    s_cmp_lg_u64 s[94:95], 0
    s_cbranch_scc1 L_nb0_59
    s_cmp_lg_u64 s[96:97], 0
    s_cbranch_scc1 L_nb1_60
    s_cmp_lg_u64 s[98:99], 0
    s_cbranch_scc1 L_nb2_61
    s_cmp_lg_u64 s[100:101], 0
    s_cbranch_scc1 L_nb3_62
    s_branch L_out_direct
L_nb0_59:
    s_ff1_i32_b64 s89, s[94:95]
    s_bitset0_b64 s[94:95], s89
    s_add_u32 s89, s89, 0
    s_branch L_nb_done_58
L_nb1_60:
    s_ff1_i32_b64 s89, s[96:97]
    s_bitset0_b64 s[96:97], s89
    s_add_u32 s89, s89, 64
    s_branch L_nb_done_58
L_nb2_61:
    s_ff1_i32_b64 s89, s[98:99]
    s_bitset0_b64 s[98:99], s89
    s_add_u32 s89, s89, 128
    s_branch L_nb_done_58
L_nb3_62:
    s_ff1_i32_b64 s89, s[100:101]
    s_bitset0_b64 s[100:101], s89
    s_add_u32 s89, s89, 192
L_nb_done_58:
    s_and_b32 s87, s22, 3
    s_add_u32 s22, s22, 1
    s_bitcmp1_b32 s21, s87
    s_cbranch_scc1 L_pa_loop
    s_add_u32 s87, s55, s89
    s_mul_i32 s87, s87, 8448
    s_lshl_b32 s88, s52, 11
    s_add_u32 s88, s88, s87
    s_add_u32 s87, s87, 8192
    buffer_load_dword v128, v249, s[32:35], s87 offen sc1
    buffer_load_dword v129, v249, s[32:35], s87 offen offset:128 sc1
    buffer_load_dwordx4 v[168:171], v60, s[32:35], s88 offen sc1
    buffer_load_dwordx4 v[172:175], v60, s[32:35], s88 offen offset:1024 sc1
    s_waitcnt vmcnt(0)
    v_max_f32 v132, v250, v128
    v_sub_f32 v130, v250, v132
    v_sub_f32 v131, v128, v132
    v_exp_f32 v130, v130
    v_exp_f32 v131, v131
    v_mov_b32 v250, v132
    v_mul_f32 v251, v251, v130
    v_fmac_f32 v251, v129, v131
    v_lshlrev_b32 v176, 16, v168
    v_and_b32 v177, 0xffff0000, v168
    v_mul_f32 v64, v64, v130
    v_mul_f32 v65, v65, v130
    v_fmac_f32 v64, v176, v131
    v_fmac_f32 v65, v177, v131
    v_lshlrev_b32 v176, 16, v169
    v_and_b32 v177, 0xffff0000, v169
    v_mul_f32 v66, v66, v130
    v_mul_f32 v67, v67, v130
    v_fmac_f32 v66, v176, v131
    v_fmac_f32 v67, v177, v131
    v_lshlrev_b32 v176, 16, v170
    v_and_b32 v177, 0xffff0000, v170
    v_mul_f32 v68, v68, v130
    v_mul_f32 v69, v69, v130
    v_fmac_f32 v68, v176, v131
    v_fmac_f32 v69, v177, v131
    v_lshlrev_b32 v176, 16, v171
    v_and_b32 v177, 0xffff0000, v171
    v_mul_f32 v70, v70, v130
    v_mul_f32 v71, v71, v130
    v_fmac_f32 v70, v176, v131
    v_fmac_f32 v71, v177, v131
    v_lshlrev_b32 v176, 16, v172
    v_and_b32 v177, 0xffff0000, v172
    v_mul_f32 v72, v72, v130
    v_mul_f32 v73, v73, v130
    v_fmac_f32 v72, v176, v131
    v_fmac_f32 v73, v177, v131
    v_lshlrev_b32 v176, 16, v173
    v_and_b32 v177, 0xffff0000, v173
    v_mul_f32 v74, v74, v130
    v_mul_f32 v75, v75, v130
    v_fmac_f32 v74, v176, v131
    v_fmac_f32 v75, v177, v131
    v_lshlrev_b32 v176, 16, v174
    v_and_b32 v177, 0xffff0000, v174
    v_mul_f32 v76, v76, v130
    v_mul_f32 v77, v77, v130
    v_fmac_f32 v76, v176, v131
    v_fmac_f32 v77, v177, v131
    v_lshlrev_b32 v176, 16, v175
    v_and_b32 v177, 0xffff0000, v175
    v_mul_f32 v78, v78, v130
    v_mul_f32 v79, v79, v130
    v_fmac_f32 v78, v176, v131
    v_fmac_f32 v79, v177, v131
    s_branch L_pa_loop
L_out_direct:
    v_rcp_f32 v130, v251
    s_and_b32 s87, s55, 15
    s_lshl_b32 s87, s87, 17
    s_lshr_b32 s88, s55, 4
    s_lshl_b32 s88, s88, 13
    s_add_u32 s87, s87, s88
    s_lshl_b32 s88, s52, 6
    s_add_u32 s87, s87, s88
    v_mul_f32 v64, v64, v130
    v_mul_f32 v65, v65, v130
    v_mul_f32 v66, v66, v130
    v_mul_f32 v67, v67, v130
    v_cvt_pk_bf16_f32 v168, v64, v65
    v_cvt_pk_bf16_f32 v169, v66, v67
    buffer_store_dwordx2 v[168:169], v248, s[24:27], s87 offen
    v_mul_f32 v68, v68, v130
    v_mul_f32 v69, v69, v130
    v_mul_f32 v70, v70, v130
    v_mul_f32 v71, v71, v130
    v_cvt_pk_bf16_f32 v170, v68, v69
    v_cvt_pk_bf16_f32 v171, v70, v71
    buffer_store_dwordx2 v[170:171], v248, s[24:27], s87 offen offset:16
    v_mul_f32 v72, v72, v130
    v_mul_f32 v73, v73, v130
    v_mul_f32 v74, v74, v130
    v_mul_f32 v75, v75, v130
    v_cvt_pk_bf16_f32 v172, v72, v73
    v_cvt_pk_bf16_f32 v173, v74, v75
    buffer_store_dwordx2 v[172:173], v248, s[24:27], s87 offen offset:32
    v_mul_f32 v76, v76, v130
    v_mul_f32 v77, v77, v130
    v_mul_f32 v78, v78, v130
    v_mul_f32 v79, v79, v130
    v_cvt_pk_bf16_f32 v174, v76, v77
    v_cvt_pk_bf16_f32 v175, v78, v79
    buffer_store_dwordx2 v[174:175], v248, s[24:27], s87 offen offset:48
L_finish:
L_exit:
    s_endpgm
L_own_publish:
    s_add_u32 s87, s55, 512
    s_mul_i32 s87, s87, 8448
    s_lshl_b32 s88, s52, 11
    s_add_u32 s88, s88, s87
    v_cvt_pk_bf16_f32 v168, v64, v65
    v_cvt_pk_bf16_f32 v169, v66, v67
    v_cvt_pk_bf16_f32 v170, v68, v69
    v_cvt_pk_bf16_f32 v171, v70, v71
    v_cvt_pk_bf16_f32 v172, v72, v73
    v_cvt_pk_bf16_f32 v173, v74, v75
    v_cvt_pk_bf16_f32 v174, v76, v77
    v_cvt_pk_bf16_f32 v175, v78, v79
    buffer_store_dwordx4 v[168:171], v60, s[32:35], s88 offen sc1
    buffer_store_dwordx4 v[172:175], v60, s[32:35], s88 offen offset:1024 sc1
    v_cmp_lt_u32 vcc, 31, v1
    v_lshlrev_b32 v27, 2, v1
    s_add_u32 s87, s87, 8192
    v_cndmask_b32 v26, v250, v251, vcc
    buffer_store_dword v26, v27, s[32:35], s87 offen sc1
    s_waitcnt vmcnt(0)
    s_barrier
    s_cmp_lg_u32 s52, 0
    s_cbranch_scc1 L_finish
    s_mov_b32 s84, s55
    s_mov_b32 s93, 2
    s_and_b32 s88, s55, 63
    s_lshl_b32 s88, s88, 2
    s_lshr_b32 s87, s55, 6
    s_add_u32 s88, s88, s87
    v_mov_b32 v26, 1
    s_mov_b64 exec, 1
    buffer_store_byte v26, off, s[28:31], s88 sc0 sc1
    s_mov_b64 exec, -1
    s_waitcnt vmcnt(0)
    s_branch L_recheck
L_chain:
    s_mov_b32 s93, 3
    s_branch L_hk_flush
L_flush_ret3:
    v_mov_b32 v27, v25
    s_nop 1
    v_permlane32_swap_b32 v25, v27
    s_nop 1
    v_add_f32 v25, v25, v27
    s_sub_u32 s91, s73, s74
    s_min_u32 s91, s91, 4
    s_sub_u32 s91, s91, 1
L_spin_63:
    ds_read_b32 v26, v63
    s_waitcnt lgkmcnt(0)
    v_readfirstlane_b32 s87, v26
    s_cmp_eq_u32 s87, s20
    s_cbranch_scc1 L_spin_ok_64
    s_branch L_spin_63
L_spin_ok_64:
    v_mov_b32 v28, 1
    s_mov_b64 exec, 1
    ds_add_rtn_u32 v27, v63, v28 offset:4
    s_mov_b64 exec, -1
    s_waitcnt lgkmcnt(0)
    v_readfirstlane_b32 s90, v27
    v_add_u32 v29, 147456, v59
    s_cmp_eq_u32 s90, 0
    s_cbranch_scc1 L_ch_noread
L_spin_65:
    ds_read_b32 v26, v63 offset:8
    s_waitcnt lgkmcnt(0)
    v_readfirstlane_b32 s87, v26
    s_cmp_eq_u32 s87, s90
    s_cbranch_scc1 L_spin_ok_66
    s_branch L_spin_65
L_spin_ok_66:
    ds_read_b64 v[128:129], v29
    s_add_u32 s87, s52, 0
    s_and_b32 s87, s87, 3
    s_lshl_b32 s87, s87, 12
    s_add_u32 s87, s87, 131072
    v_add_u32 v26, s87, v60
    ds_read_b128 v[152:155], v26
    ds_read_b128 v[156:159], v26 offset:1024
    ds_read_b128 v[160:163], v26 offset:2048
    ds_read_b128 v[164:167], v26 offset:3072
    s_waitcnt lgkmcnt(4)
    v_max_f32 v132, v24, v128
    v_sub_f32 v130, v24, v132
    v_sub_f32 v131, v128, v132
    v_exp_f32 v130, v130
    v_exp_f32 v131, v131
    v_mov_b32 v24, v132
    v_mul_f32 v25, v25, v130
    v_fmac_f32 v25, v129, v131
    s_add_u32 s87, s52, 1
    s_and_b32 s87, s87, 3
    s_lshl_b32 s87, s87, 12
    s_add_u32 s87, s87, 131072
    v_add_u32 v26, s87, v60
    ds_read_b128 v[168:171], v26
    ds_read_b128 v[172:175], v26 offset:1024
    ds_read_b128 v[176:179], v26 offset:2048
    ds_read_b128 v[180:183], v26 offset:3072
    s_add_u32 s87, s52, 2
    s_and_b32 s87, s87, 3
    s_lshl_b32 s87, s87, 12
    s_add_u32 s87, s87, 131072
    v_add_u32 v26, s87, v60
    ds_read_b128 v[184:187], v26
    ds_read_b128 v[188:191], v26 offset:1024
    ds_read_b128 v[192:195], v26 offset:2048
    ds_read_b128 v[196:199], v26 offset:3072
    s_add_u32 s87, s52, 3
    s_and_b32 s87, s87, 3
    s_lshl_b32 s87, s87, 12
    s_add_u32 s87, s87, 131072
    v_add_u32 v26, s87, v60
    ds_read_b128 v[200:203], v26
    ds_read_b128 v[204:207], v26 offset:1024
    ds_read_b128 v[208:211], v26 offset:2048
    ds_read_b128 v[212:215], v26 offset:3072
    v_mul_f32 v64, v64, v130
    v_mul_f32 v65, v65, v130
    v_mul_f32 v66, v66, v130
    v_mul_f32 v67, v67, v130
    v_mul_f32 v68, v68, v130
    v_mul_f32 v69, v69, v130
    v_mul_f32 v70, v70, v130
    v_mul_f32 v71, v71, v130
    v_mul_f32 v72, v72, v130
    v_mul_f32 v73, v73, v130
    v_mul_f32 v74, v74, v130
    v_mul_f32 v75, v75, v130
    v_mul_f32 v76, v76, v130
    v_mul_f32 v77, v77, v130
    v_mul_f32 v78, v78, v130
    v_mul_f32 v79, v79, v130
    v_mul_f32 v80, v80, v130
    v_mul_f32 v81, v81, v130
    v_mul_f32 v82, v82, v130
    v_mul_f32 v83, v83, v130
    v_mul_f32 v84, v84, v130
    v_mul_f32 v85, v85, v130
    v_mul_f32 v86, v86, v130
    v_mul_f32 v87, v87, v130
    v_mul_f32 v88, v88, v130
    v_mul_f32 v89, v89, v130
    v_mul_f32 v90, v90, v130
    v_mul_f32 v91, v91, v130
    v_mul_f32 v92, v92, v130
    v_mul_f32 v93, v93, v130
    v_mul_f32 v94, v94, v130
    v_mul_f32 v95, v95, v130
    v_mul_f32 v96, v96, v130
    v_mul_f32 v97, v97, v130
    v_mul_f32 v98, v98, v130
    v_mul_f32 v99, v99, v130
    v_mul_f32 v100, v100, v130
    v_mul_f32 v101, v101, v130
    v_mul_f32 v102, v102, v130
    v_mul_f32 v103, v103, v130
    v_mul_f32 v104, v104, v130
    v_mul_f32 v105, v105, v130
    v_mul_f32 v106, v106, v130
    v_mul_f32 v107, v107, v130
    v_mul_f32 v108, v108, v130
    v_mul_f32 v109, v109, v130
    v_mul_f32 v110, v110, v130
    v_mul_f32 v111, v111, v130
    v_mul_f32 v112, v112, v130
    v_mul_f32 v113, v113, v130
    v_mul_f32 v114, v114, v130
    v_mul_f32 v115, v115, v130
    v_mul_f32 v116, v116, v130
    v_mul_f32 v117, v117, v130
    v_mul_f32 v118, v118, v130
    v_mul_f32 v119, v119, v130
    v_mul_f32 v120, v120, v130
    v_mul_f32 v121, v121, v130
    v_mul_f32 v122, v122, v130
    v_mul_f32 v123, v123, v130
    v_mul_f32 v124, v124, v130
    v_mul_f32 v125, v125, v130
    v_mul_f32 v126, v126, v130
    v_mul_f32 v127, v127, v130
    s_waitcnt lgkmcnt(0)
    v_fmac_f32 v64, v152, v131
    v_fmac_f32 v65, v153, v131
    v_fmac_f32 v66, v154, v131
    v_fmac_f32 v67, v155, v131
    v_fmac_f32 v68, v156, v131
    v_fmac_f32 v69, v157, v131
    v_fmac_f32 v70, v158, v131
    v_fmac_f32 v71, v159, v131
    v_fmac_f32 v72, v160, v131
    v_fmac_f32 v73, v161, v131
    v_fmac_f32 v74, v162, v131
    v_fmac_f32 v75, v163, v131
    v_fmac_f32 v76, v164, v131
    v_fmac_f32 v77, v165, v131
    v_fmac_f32 v78, v166, v131
    v_fmac_f32 v79, v167, v131
    v_fmac_f32 v80, v168, v131
    v_fmac_f32 v81, v169, v131
    v_fmac_f32 v82, v170, v131
    v_fmac_f32 v83, v171, v131
    v_fmac_f32 v84, v172, v131
    v_fmac_f32 v85, v173, v131
    v_fmac_f32 v86, v174, v131
    v_fmac_f32 v87, v175, v131
    v_fmac_f32 v88, v176, v131
    v_fmac_f32 v89, v177, v131
    v_fmac_f32 v90, v178, v131
    v_fmac_f32 v91, v179, v131
    v_fmac_f32 v92, v180, v131
    v_fmac_f32 v93, v181, v131
    v_fmac_f32 v94, v182, v131
    v_fmac_f32 v95, v183, v131
    v_fmac_f32 v96, v184, v131
    v_fmac_f32 v97, v185, v131
    v_fmac_f32 v98, v186, v131
    v_fmac_f32 v99, v187, v131
    v_fmac_f32 v100, v188, v131
    v_fmac_f32 v101, v189, v131
    v_fmac_f32 v102, v190, v131
    v_fmac_f32 v103, v191, v131
    v_fmac_f32 v104, v192, v131
    v_fmac_f32 v105, v193, v131
    v_fmac_f32 v106, v194, v131
    v_fmac_f32 v107, v195, v131
    v_fmac_f32 v108, v196, v131
    v_fmac_f32 v109, v197, v131
    v_fmac_f32 v110, v198, v131
    v_fmac_f32 v111, v199, v131
    v_fmac_f32 v112, v200, v131
    v_fmac_f32 v113, v201, v131
    v_fmac_f32 v114, v202, v131
    v_fmac_f32 v115, v203, v131
    v_fmac_f32 v116, v204, v131
    v_fmac_f32 v117, v205, v131
    v_fmac_f32 v118, v206, v131
    v_fmac_f32 v119, v207, v131
    v_fmac_f32 v120, v208, v131
    v_fmac_f32 v121, v209, v131
    v_fmac_f32 v122, v210, v131
    v_fmac_f32 v123, v211, v131
    v_fmac_f32 v124, v212, v131
    v_fmac_f32 v125, v213, v131
    v_fmac_f32 v126, v214, v131
    v_fmac_f32 v127, v215, v131
L_ch_noread:
    s_cmp_eq_u32 s90, s91
    s_cbranch_scc1 L_ch_publish
    ds_write_b64 v29, v[24:25]
    s_add_u32 s87, s52, 0
    s_and_b32 s87, s87, 3
    s_lshl_b32 s87, s87, 12
    s_add_u32 s87, s87, 131072
    v_add_u32 v26, s87, v60
    ds_write_b128 v26, v[64:67]
    ds_write_b128 v26, v[68:71] offset:1024
    ds_write_b128 v26, v[72:75] offset:2048
    ds_write_b128 v26, v[76:79] offset:3072
    s_add_u32 s87, s52, 1
    s_and_b32 s87, s87, 3
    s_lshl_b32 s87, s87, 12
    s_add_u32 s87, s87, 131072
    v_add_u32 v26, s87, v60
    ds_write_b128 v26, v[80:83]
    ds_write_b128 v26, v[84:87] offset:1024
    ds_write_b128 v26, v[88:91] offset:2048
    ds_write_b128 v26, v[92:95] offset:3072
    s_add_u32 s87, s52, 2
    s_and_b32 s87, s87, 3
    s_lshl_b32 s87, s87, 12
    s_add_u32 s87, s87, 131072
    v_add_u32 v26, s87, v60
    ds_write_b128 v26, v[96:99]
    ds_write_b128 v26, v[100:103] offset:1024
    ds_write_b128 v26, v[104:107] offset:2048
    ds_write_b128 v26, v[108:111] offset:3072
    s_add_u32 s87, s52, 3
    s_and_b32 s87, s87, 3
    s_lshl_b32 s87, s87, 12
    s_add_u32 s87, s87, 131072
    v_add_u32 v26, s87, v60
    ds_write_b128 v26, v[112:115]
    ds_write_b128 v26, v[116:119] offset:1024
    ds_write_b128 v26, v[120:123] offset:2048
    ds_write_b128 v26, v[124:127] offset:3072
    s_waitcnt lgkmcnt(0)
    s_mov_b64 exec, 1
    ds_add_u32 v63, v28 offset:8
    s_mov_b64 exec, -1
    s_add_u32 s20, s20, 1
    s_branch L_next_seg
L_ch_publish:
    s_add_u32 s20, s20, 1
    v_mov_b32 v28, 0
    v_mov_b32 v29, s20
    ds_write_b32 v63, v28 offset:4
    ds_write_b32 v63, v28 offset:8
    ds_write_b32 v63, v29
    v_cvt_pk_bf16_f32 v152, v64, v65
    v_cvt_pk_bf16_f32 v153, v66, v67
    v_cvt_pk_bf16_f32 v154, v68, v69
    v_cvt_pk_bf16_f32 v155, v70, v71
    v_cvt_pk_bf16_f32 v156, v72, v73
    v_cvt_pk_bf16_f32 v157, v74, v75
    v_cvt_pk_bf16_f32 v158, v76, v77
    v_cvt_pk_bf16_f32 v159, v78, v79
    v_cvt_pk_bf16_f32 v160, v80, v81
    v_cvt_pk_bf16_f32 v161, v82, v83
    v_cvt_pk_bf16_f32 v162, v84, v85
    v_cvt_pk_bf16_f32 v163, v86, v87
    v_cvt_pk_bf16_f32 v164, v88, v89
    v_cvt_pk_bf16_f32 v165, v90, v91
    v_cvt_pk_bf16_f32 v166, v92, v93
    v_cvt_pk_bf16_f32 v167, v94, v95
    v_cvt_pk_bf16_f32 v168, v96, v97
    v_cvt_pk_bf16_f32 v169, v98, v99
    v_cvt_pk_bf16_f32 v170, v100, v101
    v_cvt_pk_bf16_f32 v171, v102, v103
    v_cvt_pk_bf16_f32 v172, v104, v105
    v_cvt_pk_bf16_f32 v173, v106, v107
    v_cvt_pk_bf16_f32 v174, v108, v109
    v_cvt_pk_bf16_f32 v175, v110, v111
    v_cvt_pk_bf16_f32 v176, v112, v113
    v_cvt_pk_bf16_f32 v177, v114, v115
    v_cvt_pk_bf16_f32 v178, v116, v117
    v_cvt_pk_bf16_f32 v179, v118, v119
    v_cvt_pk_bf16_f32 v180, v120, v121
    v_cvt_pk_bf16_f32 v181, v122, v123
    v_cvt_pk_bf16_f32 v182, v124, v125
    v_cvt_pk_bf16_f32 v183, v126, v127
    v_accvgpr_write_b32 a132, v152
    v_accvgpr_write_b32 a133, v153
    v_accvgpr_write_b32 a134, v154
    v_accvgpr_write_b32 a135, v155
    v_accvgpr_write_b32 a136, v156
    v_accvgpr_write_b32 a137, v157
    v_accvgpr_write_b32 a138, v158
    v_accvgpr_write_b32 a139, v159
    v_accvgpr_write_b32 a140, v160
    v_accvgpr_write_b32 a141, v161
    v_accvgpr_write_b32 a142, v162
    v_accvgpr_write_b32 a143, v163
    v_accvgpr_write_b32 a144, v164
    v_accvgpr_write_b32 a145, v165
    v_accvgpr_write_b32 a146, v166
    v_accvgpr_write_b32 a147, v167
    v_accvgpr_write_b32 a148, v168
    v_accvgpr_write_b32 a149, v169
    v_accvgpr_write_b32 a150, v170
    v_accvgpr_write_b32 a151, v171
    v_accvgpr_write_b32 a152, v172
    v_accvgpr_write_b32 a153, v173
    v_accvgpr_write_b32 a154, v174
    v_accvgpr_write_b32 a155, v175
    v_accvgpr_write_b32 a156, v176
    v_accvgpr_write_b32 a157, v177
    v_accvgpr_write_b32 a158, v178
    v_accvgpr_write_b32 a159, v179
    v_accvgpr_write_b32 a160, v180
    v_accvgpr_write_b32 a161, v181
    v_accvgpr_write_b32 a162, v182
    v_accvgpr_write_b32 a163, v183
    v_accvgpr_write_b32 a164, v24
    v_accvgpr_write_b32 a165, v25
    s_mov_b32 s84, s75
    s_sub_u32 s86, s20, 1
    s_mov_b32 s83, 8
    s_mov_b32 s82, 1
    s_branch L_next_seg
L_hk:
    s_sub_u32 s82, s82, 1
    s_cmp_lg_u32 s82, 0
    s_cbranch_scc1 L_hk_ret
    s_mov_b32 s93, 0
    s_cmp_eq_u32 s83, 4
    s_cbranch_scc1 L_ms_start
    s_cmp_eq_u32 s83, 5
    s_cbranch_scc1 L_ms_eval
    s_cmp_eq_u32 s83, 7
    s_cbranch_scc1 L_ms_wait
L_hk_dispatch:
    s_cmp_eq_u32 s83, 8
    s_cbranch_scc1 L_write_rec
    s_cmp_eq_u32 s83, 1
    s_cbranch_scc1 L_signal
    s_cmp_eq_u32 s83, 2
    s_cbranch_scc1 L_flagged
    s_cmp_eq_u32 s83, 3
    s_cbranch_scc1 L_check
    s_cmp_eq_u32 s83, 6
    s_cbranch_scc1 L_ms_fold
    s_branch L_hk_return
L_hk_flush:
    s_cmp_eq_u32 s82, 0
    s_cbranch_scc1 L_hk_return
    s_mov_b32 s82, 0
    s_waitcnt vmcnt(0)
    s_branch L_hk_dispatch
L_write_rec:
    s_add_u32 s88, s84, s55
    s_mul_i32 s88, s88, 8448
    v_accvgpr_read_b32 v28, a164
    v_accvgpr_read_b32 v29, a165
    s_add_u32 s87, s52, 0
    s_and_b32 s87, s87, 3
    s_lshl_b32 s87, s87, 11
    s_add_u32 s87, s87, s88
    buffer_store_dwordx4 a[132:135], v60, s[32:35], s87 offen sc1
    buffer_store_dwordx4 a[136:139], v60, s[32:35], s87 offen offset:1024 sc1
    s_add_u32 s87, s52, 1
    s_and_b32 s87, s87, 3
    s_lshl_b32 s87, s87, 11
    s_add_u32 s87, s87, s88
    buffer_store_dwordx4 a[140:143], v60, s[32:35], s87 offen sc1
    buffer_store_dwordx4 a[144:147], v60, s[32:35], s87 offen offset:1024 sc1
    s_add_u32 s87, s52, 2
    s_and_b32 s87, s87, 3
    s_lshl_b32 s87, s87, 11
    s_add_u32 s87, s87, s88
    buffer_store_dwordx4 a[148:151], v60, s[32:35], s87 offen sc1
    buffer_store_dwordx4 a[152:155], v60, s[32:35], s87 offen offset:1024 sc1
    s_add_u32 s87, s52, 3
    s_and_b32 s87, s87, 3
    s_lshl_b32 s87, s87, 11
    s_add_u32 s87, s87, s88
    buffer_store_dwordx4 a[156:159], v60, s[32:35], s87 offen sc1
    buffer_store_dwordx4 a[160:163], v60, s[32:35], s87 offen offset:1024 sc1
    v_cmp_lt_u32 vcc, 31, v1
    v_lshlrev_b32 v27, 2, v1
    s_add_u32 s88, s88, 8192
    v_cndmask_b32 v26, v28, v29, vcc
    buffer_store_dword v26, v27, s[32:35], s88 offen sc1
    s_mov_b32 s83, 1
    s_mov_b32 s82, 2
    s_cmp_eq_u32 s93, 0
    s_cbranch_scc1 L_hk_ret
    s_mov_b32 s82, 0
    s_waitcnt vmcnt(0)
L_signal:
    ds_read_b32 v26, v63 offset:12
    s_waitcnt lgkmcnt(0)
    v_readfirstlane_b32 s87, v26
    s_cmp_eq_u32 s87, s86
    s_cbranch_scc1 L_sig_go
    s_mov_b32 s82, 1
    s_cmp_eq_u32 s93, 0
    s_cbranch_scc1 L_hk_ret
    s_mov_b32 s82, 0
    s_branch L_signal
L_sig_go:
    s_cmp_lt_u32 s84, s55
    s_addc_u32 s87, s84, 0
    v_mov_b32 v26, s87
    s_and_b32 s88, s55, 63
    s_lshl_b32 s88, s88, 2
    s_lshr_b32 s87, s55, 6
    s_add_u32 s88, s88, s87
    s_mov_b64 exec, 1
    buffer_store_byte v26, off, s[28:31], s88 sc0 sc1
    s_mov_b64 exec, -1
    s_mov_b32 s83, 2
    s_mov_b32 s82, 2
    s_cmp_eq_u32 s93, 0
    s_cbranch_scc1 L_hk_ret
    s_mov_b32 s82, 0
    s_waitcnt vmcnt(0)
L_flagged:
    s_add_u32 s87, s86, 1
    v_mov_b32 v26, s87
    ds_write_b32 v63, v26 offset:12
L_recheck:
    buffer_load_dword v61, v62, s[28:31], 0 offen sc0 sc1
    s_mov_b32 s83, 3
    s_mov_b32 s82, 2
    s_cmp_eq_u32 s93, 0
    s_cbranch_scc1 L_hk_ret
    s_mov_b32 s82, 0
    s_waitcnt vmcnt(0)
L_check:
    s_and_b32 s87, s84, 63
    v_readlane_b32 s88, v61, s87
    s_lshr_b32 s87, s84, 6
    s_lshl_b32 s87, s87, 3
    s_lshr_b32 s88, s88, s87
    s_and_b32 s88, s88, 255
    s_cbranch_scc0 L_hk_return
    s_and_b32 s87, s84, 63
    s_lshr_b32 s88, s84, 6
    v_readlane_b32 s89, v40, s87
    v_readlane_b32 s3, v41, s87
    s_cmp_eq_u32 s88, 1
    s_cselect_b32 s89, s3, s89
    v_readlane_b32 s3, v42, s87
    s_cmp_eq_u32 s88, 2
    s_cselect_b32 s89, s3, s89
    v_readlane_b32 s3, v43, s87
    s_cmp_eq_u32 s88, 3
    s_cselect_b32 s89, s3, s89
    v_readlane_b32 s90, v48, s87
    v_readlane_b32 s3, v49, s87
    s_cmp_eq_u32 s88, 1
    s_cselect_b32 s90, s3, s90
    v_readlane_b32 s3, v50, s87
    s_cmp_eq_u32 s88, 2
    s_cselect_b32 s90, s3, s90
    v_readlane_b32 s3, v51, s87
    s_cmp_eq_u32 s88, 3
    s_cselect_b32 s90, s3, s90
    v_readlane_b32 s91, v44, s87
    v_readlane_b32 s3, v45, s87
    s_cmp_eq_u32 s88, 1
    s_cselect_b32 s91, s3, s91
    v_readlane_b32 s3, v46, s87
    s_cmp_eq_u32 s88, 2
    s_cselect_b32 s91, s3, s91
    v_readlane_b32 s3, v47, s87
    s_cmp_eq_u32 s88, 3
    s_cselect_b32 s91, s3, s91
    v_readlane_b32 s92, v56, s87
    s_sub_u32 s92, s92, s91
    s_lshr_b32 s3, s92, 1
    s_min_u32 s3, s3, 16
    v_mov_b32 v28, s92
    s_sub_u32 s3, s92, s3
    s_sub_u32 s91, s92, 1
    s_ashr_i32 s91, s91, 1
    s_min_i32 s91, s91, 16
    v_subrev_u32 v29, s89, v32
    v_cvt_f32_i32 v29, v29
    v_mul_f32 v29, s90, v29
    v_ceil_f32 v29, v29
    v_cvt_i32_f32 v29, v29
    v_med3_i32 v29, v29, 0, v28
    v_cmp_lt_i32 vcc, s91, v29
    s_nop 1
    v_cndmask_b32 v27, 0, v29, vcc
    v_cmp_le_i32 vcc, s3, v29
    s_nop 1
    v_cndmask_b32 v29, v27, v28, vcc
    v_subrev_u32 v26, s89, v36
    v_cvt_f32_i32 v26, v26
    v_mul_f32 v26, s90, v26
    v_ceil_f32 v26, v26
    v_cvt_i32_f32 v26, v26
    v_med3_i32 v26, v26, 0, v28
    v_cmp_lt_i32 vcc, s91, v26
    s_nop 1
    v_cndmask_b32 v27, 0, v26, vcc
    v_cmp_le_i32 vcc, s3, v26
    s_nop 1
    v_cndmask_b32 v26, v27, v28, vcc
    v_cmp_gt_i32 s[94:95], v26, v29
    v_subrev_u32 v29, s89, v33
    v_cvt_f32_i32 v29, v29
    v_mul_f32 v29, s90, v29
    v_ceil_f32 v29, v29
    v_cvt_i32_f32 v29, v29
    v_med3_i32 v29, v29, 0, v28
    v_cmp_lt_i32 vcc, s91, v29
    s_nop 1
    v_cndmask_b32 v27, 0, v29, vcc
    v_cmp_le_i32 vcc, s3, v29
    s_nop 1
    v_cndmask_b32 v29, v27, v28, vcc
    v_subrev_u32 v26, s89, v37
    v_cvt_f32_i32 v26, v26
    v_mul_f32 v26, s90, v26
    v_ceil_f32 v26, v26
    v_cvt_i32_f32 v26, v26
    v_med3_i32 v26, v26, 0, v28
    v_cmp_lt_i32 vcc, s91, v26
    s_nop 1
    v_cndmask_b32 v27, 0, v26, vcc
    v_cmp_le_i32 vcc, s3, v26
    s_nop 1
    v_cndmask_b32 v26, v27, v28, vcc
    v_cmp_gt_i32 s[96:97], v26, v29
    v_subrev_u32 v29, s89, v34
    v_cvt_f32_i32 v29, v29
    v_mul_f32 v29, s90, v29
    v_ceil_f32 v29, v29
    v_cvt_i32_f32 v29, v29
    v_med3_i32 v29, v29, 0, v28
    v_cmp_lt_i32 vcc, s91, v29
    s_nop 1
    v_cndmask_b32 v27, 0, v29, vcc
    v_cmp_le_i32 vcc, s3, v29
    s_nop 1
    v_cndmask_b32 v29, v27, v28, vcc
    v_subrev_u32 v26, s89, v38
    v_cvt_f32_i32 v26, v26
    v_mul_f32 v26, s90, v26
    v_ceil_f32 v26, v26
    v_cvt_i32_f32 v26, v26
    v_med3_i32 v26, v26, 0, v28
    v_cmp_lt_i32 vcc, s91, v26
    s_nop 1
    v_cndmask_b32 v27, 0, v26, vcc
    v_cmp_le_i32 vcc, s3, v26
    s_nop 1
    v_cndmask_b32 v26, v27, v28, vcc
    v_cmp_gt_i32 s[98:99], v26, v29
    v_subrev_u32 v29, s89, v35
    v_cvt_f32_i32 v29, v29
    v_mul_f32 v29, s90, v29
    v_ceil_f32 v29, v29
    v_cvt_i32_f32 v29, v29
    v_med3_i32 v29, v29, 0, v28
    v_cmp_lt_i32 vcc, s91, v29
    s_nop 1
    v_cndmask_b32 v27, 0, v29, vcc
    v_cmp_le_i32 vcc, s3, v29
    s_nop 1
    v_cndmask_b32 v29, v27, v28, vcc
    v_subrev_u32 v26, s89, v39
    v_cvt_f32_i32 v26, v26
    v_mul_f32 v26, s90, v26
    v_ceil_f32 v26, v26
    v_cvt_i32_f32 v26, v26
    v_med3_i32 v26, v26, 0, v28
    v_cmp_lt_i32 vcc, s91, v26
    s_nop 1
    v_cndmask_b32 v27, 0, v26, vcc
    v_cmp_le_i32 vcc, s3, v26
    s_nop 1
    v_cndmask_b32 v26, v27, v28, vcc
    v_cmp_gt_i32 s[100:101], v26, v29
    s_nop 1
    v_mov_b32 v28, s84
    v_add_u32 v29, 1, v28
    s_mov_b64 s[88:89], 0
    v_add_u32 v26, 0, v1
    v_cmp_lt_u32 vcc, v28, v26
    v_bfe_u32 v27, v61, 0, 8
    s_nop 0
    v_cndmask_b32 v26, v28, v29, vcc
    v_cmp_lt_u32 vcc, v27, v26
    s_nop 1
    s_and_b64 s[90:91], vcc, s[94:95]
    s_or_b64 s[88:89], s[88:89], s[90:91]
    v_add_u32 v26, 64, v1
    v_cmp_lt_u32 vcc, v28, v26
    v_bfe_u32 v27, v61, 8, 8
    s_nop 0
    v_cndmask_b32 v26, v28, v29, vcc
    v_cmp_lt_u32 vcc, v27, v26
    s_nop 1
    s_and_b64 s[90:91], vcc, s[96:97]
    s_or_b64 s[88:89], s[88:89], s[90:91]
    v_add_u32 v26, 128, v1
    v_cmp_lt_u32 vcc, v28, v26
    v_bfe_u32 v27, v61, 16, 8
    s_nop 0
    v_cndmask_b32 v26, v28, v29, vcc
    v_cmp_lt_u32 vcc, v27, v26
    s_nop 1
    s_and_b64 s[90:91], vcc, s[98:99]
    s_or_b64 s[88:89], s[88:89], s[90:91]
    v_add_u32 v26, 192, v1
    v_cmp_lt_u32 vcc, v28, v26
    v_bfe_u32 v27, v61, 24, 8
    s_nop 0
    v_cndmask_b32 v26, v28, v29, vcc
    v_cmp_lt_u32 vcc, v27, v26
    s_nop 1
    s_and_b64 s[90:91], vcc, s[100:101]
    s_or_b64 s[88:89], s[88:89], s[90:91]
    s_cbranch_scc1 L_hk_return
    s_mov_b32 s85, 0
L_pb_dt:
    v_mov_b32 v152, 0
    v_mov_b32 v153, 0
    v_mov_b32 v154, 0
    v_mov_b32 v155, 0
    v_mov_b32 v156, 0
    v_mov_b32 v157, 0
    v_mov_b32 v158, 0
    v_mov_b32 v159, 0
    v_mov_b32 v160, 0
    v_mov_b32 v161, 0
    v_mov_b32 v162, 0
    v_mov_b32 v163, 0
    v_mov_b32 v164, 0
    v_mov_b32 v165, 0
    v_mov_b32 v166, 0
    v_mov_b32 v167, 0
    v_mov_b32 v136, 0xff61b1e6
    v_mov_b32 v137, 0
    s_and_b32 s87, s84, 63
    s_lshr_b32 s88, s84, 6
    v_readlane_b32 s89, v40, s87
    v_readlane_b32 s3, v41, s87
    s_cmp_eq_u32 s88, 1
    s_cselect_b32 s89, s3, s89
    v_readlane_b32 s3, v42, s87
    s_cmp_eq_u32 s88, 2
    s_cselect_b32 s89, s3, s89
    v_readlane_b32 s3, v43, s87
    s_cmp_eq_u32 s88, 3
    s_cselect_b32 s89, s3, s89
    v_readlane_b32 s90, v48, s87
    v_readlane_b32 s3, v49, s87
    s_cmp_eq_u32 s88, 1
    s_cselect_b32 s90, s3, s90
    v_readlane_b32 s3, v50, s87
    s_cmp_eq_u32 s88, 2
    s_cselect_b32 s90, s3, s90
    v_readlane_b32 s3, v51, s87
    s_cmp_eq_u32 s88, 3
    s_cselect_b32 s90, s3, s90
    v_readlane_b32 s91, v44, s87
    v_readlane_b32 s3, v45, s87
    s_cmp_eq_u32 s88, 1
    s_cselect_b32 s91, s3, s91
    v_readlane_b32 s3, v46, s87
    s_cmp_eq_u32 s88, 2
    s_cselect_b32 s91, s3, s91
    v_readlane_b32 s3, v47, s87
    s_cmp_eq_u32 s88, 3
    s_cselect_b32 s91, s3, s91
    v_readlane_b32 s92, v56, s87
    s_sub_u32 s92, s92, s91
    s_lshr_b32 s3, s92, 1
    s_min_u32 s3, s3, 16
    v_mov_b32 v28, s92
    s_sub_u32 s3, s92, s3
    s_sub_u32 s91, s92, 1
    s_ashr_i32 s91, s91, 1
    s_min_i32 s91, s91, 16
    v_subrev_u32 v29, s89, v32
    v_cvt_f32_i32 v29, v29
    v_mul_f32 v29, s90, v29
    v_ceil_f32 v29, v29
    v_cvt_i32_f32 v29, v29
    v_med3_i32 v29, v29, 0, v28
    v_cmp_lt_i32 vcc, s91, v29
    s_nop 1
    v_cndmask_b32 v27, 0, v29, vcc
    v_cmp_le_i32 vcc, s3, v29
    s_nop 1
    v_cndmask_b32 v29, v27, v28, vcc
    v_subrev_u32 v26, s89, v36
    v_cvt_f32_i32 v26, v26
    v_mul_f32 v26, s90, v26
    v_ceil_f32 v26, v26
    v_cvt_i32_f32 v26, v26
    v_med3_i32 v26, v26, 0, v28
    v_cmp_lt_i32 vcc, s91, v26
    s_nop 1
    v_cndmask_b32 v27, 0, v26, vcc
    v_cmp_le_i32 vcc, s3, v26
    s_nop 1
    v_cndmask_b32 v26, v27, v28, vcc
    v_cmp_gt_i32 s[94:95], v26, v29
    v_subrev_u32 v29, s89, v33
    v_cvt_f32_i32 v29, v29
    v_mul_f32 v29, s90, v29
    v_ceil_f32 v29, v29
    v_cvt_i32_f32 v29, v29
    v_med3_i32 v29, v29, 0, v28
    v_cmp_lt_i32 vcc, s91, v29
    s_nop 1
    v_cndmask_b32 v27, 0, v29, vcc
    v_cmp_le_i32 vcc, s3, v29
    s_nop 1
    v_cndmask_b32 v29, v27, v28, vcc
    v_subrev_u32 v26, s89, v37
    v_cvt_f32_i32 v26, v26
    v_mul_f32 v26, s90, v26
    v_ceil_f32 v26, v26
    v_cvt_i32_f32 v26, v26
    v_med3_i32 v26, v26, 0, v28
    v_cmp_lt_i32 vcc, s91, v26
    s_nop 1
    v_cndmask_b32 v27, 0, v26, vcc
    v_cmp_le_i32 vcc, s3, v26
    s_nop 1
    v_cndmask_b32 v26, v27, v28, vcc
    v_cmp_gt_i32 s[96:97], v26, v29
    v_subrev_u32 v29, s89, v34
    v_cvt_f32_i32 v29, v29
    v_mul_f32 v29, s90, v29
    v_ceil_f32 v29, v29
    v_cvt_i32_f32 v29, v29
    v_med3_i32 v29, v29, 0, v28
    v_cmp_lt_i32 vcc, s91, v29
    s_nop 1
    v_cndmask_b32 v27, 0, v29, vcc
    v_cmp_le_i32 vcc, s3, v29
    s_nop 1
    v_cndmask_b32 v29, v27, v28, vcc
    v_subrev_u32 v26, s89, v38
    v_cvt_f32_i32 v26, v26
    v_mul_f32 v26, s90, v26
    v_ceil_f32 v26, v26
    v_cvt_i32_f32 v26, v26
    v_med3_i32 v26, v26, 0, v28
    v_cmp_lt_i32 vcc, s91, v26
    s_nop 1
    v_cndmask_b32 v27, 0, v26, vcc
    v_cmp_le_i32 vcc, s3, v26
    s_nop 1
    v_cndmask_b32 v26, v27, v28, vcc
    v_cmp_gt_i32 s[98:99], v26, v29
    v_subrev_u32 v29, s89, v35
    v_cvt_f32_i32 v29, v29
    v_mul_f32 v29, s90, v29
    v_ceil_f32 v29, v29
    v_cvt_i32_f32 v29, v29
    v_med3_i32 v29, v29, 0, v28
    v_cmp_lt_i32 vcc, s91, v29
    s_nop 1
    v_cndmask_b32 v27, 0, v29, vcc
    v_cmp_le_i32 vcc, s3, v29
    s_nop 1
    v_cndmask_b32 v29, v27, v28, vcc
    v_subrev_u32 v26, s89, v39
    v_cvt_f32_i32 v26, v26
    v_mul_f32 v26, s90, v26
    v_ceil_f32 v26, v26
    v_cvt_i32_f32 v26, v26
    v_med3_i32 v26, v26, 0, v28
    v_cmp_lt_i32 vcc, s91, v26
    s_nop 1
    v_cndmask_b32 v27, 0, v26, vcc
    v_cmp_le_i32 vcc, s3, v26
    s_nop 1
    v_cndmask_b32 v26, v27, v28, vcc
    v_cmp_gt_i32 s[100:101], v26, v29
    s_nop 1
    s_mov_b32 s89, 512
L_pb_loop:
    s_add_u32 s87, s84, s89
    s_mul_i32 s87, s87, 8448
    s_lshl_b32 s88, s85, 11
    s_add_u32 s88, s88, s87
    s_add_u32 s87, s87, 8192
    buffer_load_dword v128, v249, s[32:35], s87 offen sc1
    buffer_load_dword v129, v249, s[32:35], s87 offen offset:128 sc1
    buffer_load_dwordx4 v[168:171], v60, s[32:35], s88 offen sc1
    buffer_load_dwordx4 v[172:175], v60, s[32:35], s88 offen offset:1024 sc1
    s_waitcnt vmcnt(0)
    v_max_f32 v132, v136, v128
    v_sub_f32 v130, v136, v132
    v_sub_f32 v131, v128, v132
    v_exp_f32 v130, v130
    v_exp_f32 v131, v131
    v_mov_b32 v136, v132
    v_mul_f32 v137, v137, v130
    v_fmac_f32 v137, v129, v131
    v_lshlrev_b32 v176, 16, v168
    v_and_b32 v177, 0xffff0000, v168
    v_mul_f32 v152, v152, v130
    v_mul_f32 v153, v153, v130
    v_fmac_f32 v152, v176, v131
    v_fmac_f32 v153, v177, v131
    v_lshlrev_b32 v176, 16, v169
    v_and_b32 v177, 0xffff0000, v169
    v_mul_f32 v154, v154, v130
    v_mul_f32 v155, v155, v130
    v_fmac_f32 v154, v176, v131
    v_fmac_f32 v155, v177, v131
    v_lshlrev_b32 v176, 16, v170
    v_and_b32 v177, 0xffff0000, v170
    v_mul_f32 v156, v156, v130
    v_mul_f32 v157, v157, v130
    v_fmac_f32 v156, v176, v131
    v_fmac_f32 v157, v177, v131
    v_lshlrev_b32 v176, 16, v171
    v_and_b32 v177, 0xffff0000, v171
    v_mul_f32 v158, v158, v130
    v_mul_f32 v159, v159, v130
    v_fmac_f32 v158, v176, v131
    v_fmac_f32 v159, v177, v131
    v_lshlrev_b32 v176, 16, v172
    v_and_b32 v177, 0xffff0000, v172
    v_mul_f32 v160, v160, v130
    v_mul_f32 v161, v161, v130
    v_fmac_f32 v160, v176, v131
    v_fmac_f32 v161, v177, v131
    v_lshlrev_b32 v176, 16, v173
    v_and_b32 v177, 0xffff0000, v173
    v_mul_f32 v162, v162, v130
    v_mul_f32 v163, v163, v130
    v_fmac_f32 v162, v176, v131
    v_fmac_f32 v163, v177, v131
    v_lshlrev_b32 v176, 16, v174
    v_and_b32 v177, 0xffff0000, v174
    v_mul_f32 v164, v164, v130
    v_mul_f32 v165, v165, v130
    v_fmac_f32 v164, v176, v131
    v_fmac_f32 v165, v177, v131
    v_lshlrev_b32 v176, 16, v175
    v_and_b32 v177, 0xffff0000, v175
    v_mul_f32 v166, v166, v130
    v_mul_f32 v167, v167, v130
    v_fmac_f32 v166, v176, v131
    v_fmac_f32 v167, v177, v131
    s_cmp_lg_u64 s[94:95], 0
    s_cbranch_scc1 L_nb0_68
    s_cmp_lg_u64 s[96:97], 0
    s_cbranch_scc1 L_nb1_69
    s_cmp_lg_u64 s[98:99], 0
    s_cbranch_scc1 L_nb2_70
    s_cmp_lg_u64 s[100:101], 0
    s_cbranch_scc1 L_nb3_71
    s_branch L_pb_store
L_nb0_68:
    s_ff1_i32_b64 s89, s[94:95]
    s_bitset0_b64 s[94:95], s89
    s_add_u32 s89, s89, 0
    s_branch L_nb_done_67
L_nb1_69:
    s_ff1_i32_b64 s89, s[96:97]
    s_bitset0_b64 s[96:97], s89
    s_add_u32 s89, s89, 64
    s_branch L_nb_done_67
L_nb2_70:
    s_ff1_i32_b64 s89, s[98:99]
    s_bitset0_b64 s[98:99], s89
    s_add_u32 s89, s89, 128
    s_branch L_nb_done_67
L_nb3_71:
    s_ff1_i32_b64 s89, s[100:101]
    s_bitset0_b64 s[100:101], s89
    s_add_u32 s89, s89, 192
L_nb_done_67:
    s_branch L_pb_loop
L_pb_store:
    v_rcp_f32 v130, v137
    s_and_b32 s87, s84, 15
    s_lshl_b32 s87, s87, 17
    s_lshr_b32 s88, s84, 4
    s_lshl_b32 s88, s88, 13
    s_add_u32 s87, s87, s88
    s_lshl_b32 s88, s85, 6
    s_add_u32 s87, s87, s88
    v_mul_f32 v152, v152, v130
    v_mul_f32 v153, v153, v130
    v_mul_f32 v154, v154, v130
    v_mul_f32 v155, v155, v130
    v_cvt_pk_bf16_f32 v168, v152, v153
    v_cvt_pk_bf16_f32 v169, v154, v155
    buffer_store_dwordx2 v[168:169], v248, s[24:27], s87 offen
    v_mul_f32 v156, v156, v130
    v_mul_f32 v157, v157, v130
    v_mul_f32 v158, v158, v130
    v_mul_f32 v159, v159, v130
    v_cvt_pk_bf16_f32 v170, v156, v157
    v_cvt_pk_bf16_f32 v171, v158, v159
    buffer_store_dwordx2 v[170:171], v248, s[24:27], s87 offen offset:16
    v_mul_f32 v160, v160, v130
    v_mul_f32 v161, v161, v130
    v_mul_f32 v162, v162, v130
    v_mul_f32 v163, v163, v130
    v_cvt_pk_bf16_f32 v172, v160, v161
    v_cvt_pk_bf16_f32 v173, v162, v163
    buffer_store_dwordx2 v[172:173], v248, s[24:27], s87 offen offset:32
    v_mul_f32 v164, v164, v130
    v_mul_f32 v165, v165, v130
    v_mul_f32 v166, v166, v130
    v_mul_f32 v167, v167, v130
    v_cvt_pk_bf16_f32 v174, v164, v165
    v_cvt_pk_bf16_f32 v175, v166, v167
    buffer_store_dwordx2 v[174:175], v248, s[24:27], s87 offen offset:48
    s_add_u32 s85, s85, 1
    s_cmp_lt_u32 s85, 4
    s_cbranch_scc1 L_pb_dt
    s_mov_b32 s85, 0
L_hk_return:
    s_cmp_eq_u32 s93, 0
    s_cbranch_scc1 L_hk_ret
    s_cmp_eq_u32 s93, 1
    s_cbranch_scc1 L_flush_ret1
    s_cmp_eq_u32 s93, 3
    s_cbranch_scc1 L_flush_ret3
    s_branch L_finish
L_ms_start:
    buffer_load_dword v61, v62, s[28:31], 0 offen sc0 sc1
    s_mov_b32 s83, 5
    s_mov_b32 s82, 2
    s_branch L_hk_ret
L_ms_eval:
    s_and_b32 s87, s55, 63
    s_lshr_b32 s88, s55, 6
    v_readlane_b32 s89, v40, s87
    v_readlane_b32 s3, v41, s87
    s_cmp_eq_u32 s88, 1
    s_cselect_b32 s89, s3, s89
    v_readlane_b32 s3, v42, s87
    s_cmp_eq_u32 s88, 2
    s_cselect_b32 s89, s3, s89
    v_readlane_b32 s3, v43, s87
    s_cmp_eq_u32 s88, 3
    s_cselect_b32 s89, s3, s89
    v_readlane_b32 s90, v48, s87
    v_readlane_b32 s3, v49, s87
    s_cmp_eq_u32 s88, 1
    s_cselect_b32 s90, s3, s90
    v_readlane_b32 s3, v50, s87
    s_cmp_eq_u32 s88, 2
    s_cselect_b32 s90, s3, s90
    v_readlane_b32 s3, v51, s87
    s_cmp_eq_u32 s88, 3
    s_cselect_b32 s90, s3, s90
    v_readlane_b32 s91, v44, s87
    v_readlane_b32 s3, v45, s87
    s_cmp_eq_u32 s88, 1
    s_cselect_b32 s91, s3, s91
    v_readlane_b32 s3, v46, s87
    s_cmp_eq_u32 s88, 2
    s_cselect_b32 s91, s3, s91
    v_readlane_b32 s3, v47, s87
    s_cmp_eq_u32 s88, 3
    s_cselect_b32 s91, s3, s91
    v_readlane_b32 s92, v56, s87
    s_sub_u32 s92, s92, s91
    s_lshr_b32 s3, s92, 1
    s_min_u32 s3, s3, 16
    v_mov_b32 v28, s92
    s_sub_u32 s3, s92, s3
    s_sub_u32 s91, s92, 1
    s_ashr_i32 s91, s91, 1
    s_min_i32 s91, s91, 16
    v_subrev_u32 v29, s89, v32
    v_cvt_f32_i32 v29, v29
    v_mul_f32 v29, s90, v29
    v_ceil_f32 v29, v29
    v_cvt_i32_f32 v29, v29
    v_med3_i32 v29, v29, 0, v28
    v_cmp_lt_i32 vcc, s91, v29
    s_nop 1
    v_cndmask_b32 v27, 0, v29, vcc
    v_cmp_le_i32 vcc, s3, v29
    s_nop 1
    v_cndmask_b32 v29, v27, v28, vcc
    v_subrev_u32 v26, s89, v36
    v_cvt_f32_i32 v26, v26
    v_mul_f32 v26, s90, v26
    v_ceil_f32 v26, v26
    v_cvt_i32_f32 v26, v26
    v_med3_i32 v26, v26, 0, v28
    v_cmp_lt_i32 vcc, s91, v26
    s_nop 1
    v_cndmask_b32 v27, 0, v26, vcc
    v_cmp_le_i32 vcc, s3, v26
    s_nop 1
    v_cndmask_b32 v26, v27, v28, vcc
    v_cmp_gt_i32 s[94:95], v26, v29
    v_subrev_u32 v29, s89, v33
    v_cvt_f32_i32 v29, v29
    v_mul_f32 v29, s90, v29
    v_ceil_f32 v29, v29
    v_cvt_i32_f32 v29, v29
    v_med3_i32 v29, v29, 0, v28
    v_cmp_lt_i32 vcc, s91, v29
    s_nop 1
    v_cndmask_b32 v27, 0, v29, vcc
    v_cmp_le_i32 vcc, s3, v29
    s_nop 1
    v_cndmask_b32 v29, v27, v28, vcc
    v_subrev_u32 v26, s89, v37
    v_cvt_f32_i32 v26, v26
    v_mul_f32 v26, s90, v26
    v_ceil_f32 v26, v26
    v_cvt_i32_f32 v26, v26
    v_med3_i32 v26, v26, 0, v28
    v_cmp_lt_i32 vcc, s91, v26
    s_nop 1
    v_cndmask_b32 v27, 0, v26, vcc
    v_cmp_le_i32 vcc, s3, v26
    s_nop 1
    v_cndmask_b32 v26, v27, v28, vcc
    v_cmp_gt_i32 s[96:97], v26, v29
    v_subrev_u32 v29, s89, v34
    v_cvt_f32_i32 v29, v29
    v_mul_f32 v29, s90, v29
    v_ceil_f32 v29, v29
    v_cvt_i32_f32 v29, v29
    v_med3_i32 v29, v29, 0, v28
    v_cmp_lt_i32 vcc, s91, v29
    s_nop 1
    v_cndmask_b32 v27, 0, v29, vcc
    v_cmp_le_i32 vcc, s3, v29
    s_nop 1
    v_cndmask_b32 v29, v27, v28, vcc
    v_subrev_u32 v26, s89, v38
    v_cvt_f32_i32 v26, v26
    v_mul_f32 v26, s90, v26
    v_ceil_f32 v26, v26
    v_cvt_i32_f32 v26, v26
    v_med3_i32 v26, v26, 0, v28
    v_cmp_lt_i32 vcc, s91, v26
    s_nop 1
    v_cndmask_b32 v27, 0, v26, vcc
    v_cmp_le_i32 vcc, s3, v26
    s_nop 1
    v_cndmask_b32 v26, v27, v28, vcc
    v_cmp_gt_i32 s[98:99], v26, v29
    v_subrev_u32 v29, s89, v35
    v_cvt_f32_i32 v29, v29
    v_mul_f32 v29, s90, v29
    v_ceil_f32 v29, v29
    v_cvt_i32_f32 v29, v29
    v_med3_i32 v29, v29, 0, v28
    v_cmp_lt_i32 vcc, s91, v29
    s_nop 1
    v_cndmask_b32 v27, 0, v29, vcc
    v_cmp_le_i32 vcc, s3, v29
    s_nop 1
    v_cndmask_b32 v29, v27, v28, vcc
    v_subrev_u32 v26, s89, v39
    v_cvt_f32_i32 v26, v26
    v_mul_f32 v26, s90, v26
    v_ceil_f32 v26, v26
    v_cvt_i32_f32 v26, v26
    v_med3_i32 v26, v26, 0, v28
    v_cmp_lt_i32 vcc, s91, v26
    s_nop 1
    v_cndmask_b32 v27, 0, v26, vcc
    v_cmp_le_i32 vcc, s3, v26
    s_nop 1
    v_cndmask_b32 v26, v27, v28, vcc
    v_cmp_gt_i32 s[100:101], v26, v29
    s_nop 1
    v_mov_b32 v28, s55
    v_add_u32 v29, 1, v28
    s_mov_b64 s[88:89], 0
    v_add_u32 v26, 0, v1
    v_cmp_lt_u32 vcc, v28, v26
    v_bfe_u32 v27, v61, 0, 8
    s_nop 0
    v_cndmask_b32 v26, v28, v29, vcc
    v_cmp_lt_u32 vcc, v27, v26
    s_nop 1
    s_and_b64 s[90:91], vcc, s[94:95]
    s_or_b64 s[88:89], s[88:89], s[90:91]
    v_add_u32 v26, 64, v1
    v_cmp_lt_u32 vcc, v28, v26
    v_bfe_u32 v27, v61, 8, 8
    s_nop 0
    v_cndmask_b32 v26, v28, v29, vcc
    v_cmp_lt_u32 vcc, v27, v26
    s_nop 1
    s_and_b64 s[90:91], vcc, s[96:97]
    s_or_b64 s[88:89], s[88:89], s[90:91]
    v_add_u32 v26, 128, v1
    v_cmp_lt_u32 vcc, v28, v26
    v_bfe_u32 v27, v61, 16, 8
    s_nop 0
    v_cndmask_b32 v26, v28, v29, vcc
    v_cmp_lt_u32 vcc, v27, v26
    s_nop 1
    s_and_b64 s[90:91], vcc, s[98:99]
    s_or_b64 s[88:89], s[88:89], s[90:91]
    v_add_u32 v26, 192, v1
    v_cmp_lt_u32 vcc, v28, v26
    v_bfe_u32 v27, v61, 24, 8
    s_nop 0
    v_cndmask_b32 v26, v28, v29, vcc
    v_cmp_lt_u32 vcc, v27, v26
    s_nop 1
    s_and_b64 s[90:91], vcc, s[100:101]
    s_or_b64 s[88:89], s[88:89], s[90:91]
    s_cbranch_scc1 L_ms_start
    v_mov_b32 v26, 1
    ds_write_b32 v63, v26 offset:32
    s_branch L_ms_go
L_ms_wait:
    ds_read_b32 v26, v63 offset:32
    s_mov_b32 s82, 1
    s_waitcnt lgkmcnt(0)
    v_readfirstlane_b32 s87, v26
    s_cmp_eq_u32 s87, 0
    s_cbranch_scc1 L_hk_ret
    s_mov_b32 s82, 0
    s_and_b32 s87, s55, 63
    s_lshr_b32 s88, s55, 6
    v_readlane_b32 s89, v40, s87
    v_readlane_b32 s3, v41, s87
    s_cmp_eq_u32 s88, 1
    s_cselect_b32 s89, s3, s89
    v_readlane_b32 s3, v42, s87
    s_cmp_eq_u32 s88, 2
    s_cselect_b32 s89, s3, s89
    v_readlane_b32 s3, v43, s87
    s_cmp_eq_u32 s88, 3
    s_cselect_b32 s89, s3, s89
    v_readlane_b32 s90, v48, s87
    v_readlane_b32 s3, v49, s87
    s_cmp_eq_u32 s88, 1
    s_cselect_b32 s90, s3, s90
    v_readlane_b32 s3, v50, s87
    s_cmp_eq_u32 s88, 2
    s_cselect_b32 s90, s3, s90
    v_readlane_b32 s3, v51, s87
    s_cmp_eq_u32 s88, 3
    s_cselect_b32 s90, s3, s90
    v_readlane_b32 s91, v44, s87
    v_readlane_b32 s3, v45, s87
    s_cmp_eq_u32 s88, 1
    s_cselect_b32 s91, s3, s91
    v_readlane_b32 s3, v46, s87
    s_cmp_eq_u32 s88, 2
    s_cselect_b32 s91, s3, s91
    v_readlane_b32 s3, v47, s87
    s_cmp_eq_u32 s88, 3
    s_cselect_b32 s91, s3, s91
    v_readlane_b32 s92, v56, s87
    s_sub_u32 s92, s92, s91
    s_lshr_b32 s3, s92, 1
    s_min_u32 s3, s3, 16
    v_mov_b32 v28, s92
    s_sub_u32 s3, s92, s3
    s_sub_u32 s91, s92, 1
    s_ashr_i32 s91, s91, 1
    s_min_i32 s91, s91, 16
    v_subrev_u32 v29, s89, v32
    v_cvt_f32_i32 v29, v29
    v_mul_f32 v29, s90, v29
    v_ceil_f32 v29, v29
    v_cvt_i32_f32 v29, v29
    v_med3_i32 v29, v29, 0, v28
    v_cmp_lt_i32 vcc, s91, v29
    s_nop 1
    v_cndmask_b32 v27, 0, v29, vcc
    v_cmp_le_i32 vcc, s3, v29
    s_nop 1
    v_cndmask_b32 v29, v27, v28, vcc
    v_subrev_u32 v26, s89, v36
    v_cvt_f32_i32 v26, v26
    v_mul_f32 v26, s90, v26
    v_ceil_f32 v26, v26
    v_cvt_i32_f32 v26, v26
    v_med3_i32 v26, v26, 0, v28
    v_cmp_lt_i32 vcc, s91, v26
    s_nop 1
    v_cndmask_b32 v27, 0, v26, vcc
    v_cmp_le_i32 vcc, s3, v26
    s_nop 1
    v_cndmask_b32 v26, v27, v28, vcc
    v_cmp_gt_i32 s[94:95], v26, v29
    v_subrev_u32 v29, s89, v33
    v_cvt_f32_i32 v29, v29
    v_mul_f32 v29, s90, v29
    v_ceil_f32 v29, v29
    v_cvt_i32_f32 v29, v29
    v_med3_i32 v29, v29, 0, v28
    v_cmp_lt_i32 vcc, s91, v29
    s_nop 1
    v_cndmask_b32 v27, 0, v29, vcc
    v_cmp_le_i32 vcc, s3, v29
    s_nop 1
    v_cndmask_b32 v29, v27, v28, vcc
    v_subrev_u32 v26, s89, v37
    v_cvt_f32_i32 v26, v26
    v_mul_f32 v26, s90, v26
    v_ceil_f32 v26, v26
    v_cvt_i32_f32 v26, v26
    v_med3_i32 v26, v26, 0, v28
    v_cmp_lt_i32 vcc, s91, v26
    s_nop 1
    v_cndmask_b32 v27, 0, v26, vcc
    v_cmp_le_i32 vcc, s3, v26
    s_nop 1
    v_cndmask_b32 v26, v27, v28, vcc
    v_cmp_gt_i32 s[96:97], v26, v29
    v_subrev_u32 v29, s89, v34
    v_cvt_f32_i32 v29, v29
    v_mul_f32 v29, s90, v29
    v_ceil_f32 v29, v29
    v_cvt_i32_f32 v29, v29
    v_med3_i32 v29, v29, 0, v28
    v_cmp_lt_i32 vcc, s91, v29
    s_nop 1
    v_cndmask_b32 v27, 0, v29, vcc
    v_cmp_le_i32 vcc, s3, v29
    s_nop 1
    v_cndmask_b32 v29, v27, v28, vcc
    v_subrev_u32 v26, s89, v38
    v_cvt_f32_i32 v26, v26
    v_mul_f32 v26, s90, v26
    v_ceil_f32 v26, v26
    v_cvt_i32_f32 v26, v26
    v_med3_i32 v26, v26, 0, v28
    v_cmp_lt_i32 vcc, s91, v26
    s_nop 1
    v_cndmask_b32 v27, 0, v26, vcc
    v_cmp_le_i32 vcc, s3, v26
    s_nop 1
    v_cndmask_b32 v26, v27, v28, vcc
    v_cmp_gt_i32 s[98:99], v26, v29
    v_subrev_u32 v29, s89, v35
    v_cvt_f32_i32 v29, v29
    v_mul_f32 v29, s90, v29
    v_ceil_f32 v29, v29
    v_cvt_i32_f32 v29, v29
    v_med3_i32 v29, v29, 0, v28
    v_cmp_lt_i32 vcc, s91, v29
    s_nop 1
    v_cndmask_b32 v27, 0, v29, vcc
    v_cmp_le_i32 vcc, s3, v29
    s_nop 1
    v_cndmask_b32 v29, v27, v28, vcc
    v_subrev_u32 v26, s89, v39
    v_cvt_f32_i32 v26, v26
    v_mul_f32 v26, s90, v26
    v_ceil_f32 v26, v26
    v_cvt_i32_f32 v26, v26
    v_med3_i32 v26, v26, 0, v28
    v_cmp_lt_i32 vcc, s91, v26
    s_nop 1
    v_cndmask_b32 v27, 0, v26, vcc
    v_cmp_le_i32 vcc, s3, v26
    s_nop 1
    v_cndmask_b32 v26, v27, v28, vcc
    v_cmp_gt_i32 s[100:101], v26, v29
    s_nop 1
L_ms_go:
    s_mov_b32 s22, 0
    s_branch L_ms_next
L_ms_fold:
    v_accvgpr_read_b32 v128, a128
    v_accvgpr_read_b32 v129, a129
    v_max_f32 v132, v24, v128
    v_sub_f32 v130, v24, v132
    v_sub_f32 v131, v128, v132
    v_exp_f32 v130, v130
    v_exp_f32 v131, v131
    v_mov_b32 v24, v132
    v_mul_f32 v129, 0.5, v129
    v_mul_f32 v25, v25, v130
    v_fmac_f32 v25, v129, v131
    v_accvgpr_read_b32 v152, a64
    v_accvgpr_read_b32 v153, a65
    v_accvgpr_read_b32 v154, a66
    v_accvgpr_read_b32 v155, a67
    v_accvgpr_read_b32 v156, a68
    v_accvgpr_read_b32 v157, a69
    v_accvgpr_read_b32 v158, a70
    v_accvgpr_read_b32 v159, a71
    v_accvgpr_read_b32 v160, a72
    v_accvgpr_read_b32 v161, a73
    v_accvgpr_read_b32 v162, a74
    v_accvgpr_read_b32 v163, a75
    v_accvgpr_read_b32 v164, a76
    v_accvgpr_read_b32 v165, a77
    v_accvgpr_read_b32 v166, a78
    v_accvgpr_read_b32 v167, a79
    v_accvgpr_read_b32 v168, a80
    v_accvgpr_read_b32 v169, a81
    v_accvgpr_read_b32 v170, a82
    v_accvgpr_read_b32 v171, a83
    v_accvgpr_read_b32 v172, a84
    v_accvgpr_read_b32 v173, a85
    v_accvgpr_read_b32 v174, a86
    v_accvgpr_read_b32 v175, a87
    v_accvgpr_read_b32 v176, a88
    v_accvgpr_read_b32 v177, a89
    v_accvgpr_read_b32 v178, a90
    v_accvgpr_read_b32 v179, a91
    v_accvgpr_read_b32 v180, a92
    v_accvgpr_read_b32 v181, a93
    v_accvgpr_read_b32 v182, a94
    v_accvgpr_read_b32 v183, a95
    v_lshlrev_b32 v184, 16, v152
    v_and_b32 v185, 0xffff0000, v152
    v_mul_f32 v64, v64, v130
    v_mul_f32 v65, v65, v130
    v_fmac_f32 v64, v184, v131
    v_fmac_f32 v65, v185, v131
    v_lshlrev_b32 v186, 16, v153
    v_and_b32 v187, 0xffff0000, v153
    v_mul_f32 v66, v66, v130
    v_mul_f32 v67, v67, v130
    v_fmac_f32 v66, v186, v131
    v_fmac_f32 v67, v187, v131
    v_lshlrev_b32 v184, 16, v154
    v_and_b32 v185, 0xffff0000, v154
    v_mul_f32 v68, v68, v130
    v_mul_f32 v69, v69, v130
    v_fmac_f32 v68, v184, v131
    v_fmac_f32 v69, v185, v131
    v_lshlrev_b32 v186, 16, v155
    v_and_b32 v187, 0xffff0000, v155
    v_mul_f32 v70, v70, v130
    v_mul_f32 v71, v71, v130
    v_fmac_f32 v70, v186, v131
    v_fmac_f32 v71, v187, v131
    v_lshlrev_b32 v184, 16, v156
    v_and_b32 v185, 0xffff0000, v156
    v_mul_f32 v72, v72, v130
    v_mul_f32 v73, v73, v130
    v_fmac_f32 v72, v184, v131
    v_fmac_f32 v73, v185, v131
    v_lshlrev_b32 v186, 16, v157
    v_and_b32 v187, 0xffff0000, v157
    v_mul_f32 v74, v74, v130
    v_mul_f32 v75, v75, v130
    v_fmac_f32 v74, v186, v131
    v_fmac_f32 v75, v187, v131
    v_lshlrev_b32 v184, 16, v158
    v_and_b32 v185, 0xffff0000, v158
    v_mul_f32 v76, v76, v130
    v_mul_f32 v77, v77, v130
    v_fmac_f32 v76, v184, v131
    v_fmac_f32 v77, v185, v131
    v_lshlrev_b32 v186, 16, v159
    v_and_b32 v187, 0xffff0000, v159
    v_mul_f32 v78, v78, v130
    v_mul_f32 v79, v79, v130
    v_fmac_f32 v78, v186, v131
    v_fmac_f32 v79, v187, v131
    v_lshlrev_b32 v184, 16, v160
    v_and_b32 v185, 0xffff0000, v160
    v_mul_f32 v80, v80, v130
    v_mul_f32 v81, v81, v130
    v_fmac_f32 v80, v184, v131
    v_fmac_f32 v81, v185, v131
    v_lshlrev_b32 v186, 16, v161
    v_and_b32 v187, 0xffff0000, v161
    v_mul_f32 v82, v82, v130
    v_mul_f32 v83, v83, v130
    v_fmac_f32 v82, v186, v131
    v_fmac_f32 v83, v187, v131
    v_lshlrev_b32 v184, 16, v162
    v_and_b32 v185, 0xffff0000, v162
    v_mul_f32 v84, v84, v130
    v_mul_f32 v85, v85, v130
    v_fmac_f32 v84, v184, v131
    v_fmac_f32 v85, v185, v131
    v_lshlrev_b32 v186, 16, v163
    v_and_b32 v187, 0xffff0000, v163
    v_mul_f32 v86, v86, v130
    v_mul_f32 v87, v87, v130
    v_fmac_f32 v86, v186, v131
    v_fmac_f32 v87, v187, v131
    v_lshlrev_b32 v184, 16, v164
    v_and_b32 v185, 0xffff0000, v164
    v_mul_f32 v88, v88, v130
    v_mul_f32 v89, v89, v130
    v_fmac_f32 v88, v184, v131
    v_fmac_f32 v89, v185, v131
    v_lshlrev_b32 v186, 16, v165
    v_and_b32 v187, 0xffff0000, v165
    v_mul_f32 v90, v90, v130
    v_mul_f32 v91, v91, v130
    v_fmac_f32 v90, v186, v131
    v_fmac_f32 v91, v187, v131
    v_lshlrev_b32 v184, 16, v166
    v_and_b32 v185, 0xffff0000, v166
    v_mul_f32 v92, v92, v130
    v_mul_f32 v93, v93, v130
    v_fmac_f32 v92, v184, v131
    v_fmac_f32 v93, v185, v131
    v_lshlrev_b32 v186, 16, v167
    v_and_b32 v187, 0xffff0000, v167
    v_mul_f32 v94, v94, v130
    v_mul_f32 v95, v95, v130
    v_fmac_f32 v94, v186, v131
    v_fmac_f32 v95, v187, v131
    v_lshlrev_b32 v184, 16, v168
    v_and_b32 v185, 0xffff0000, v168
    v_mul_f32 v96, v96, v130
    v_mul_f32 v97, v97, v130
    v_fmac_f32 v96, v184, v131
    v_fmac_f32 v97, v185, v131
    v_lshlrev_b32 v186, 16, v169
    v_and_b32 v187, 0xffff0000, v169
    v_mul_f32 v98, v98, v130
    v_mul_f32 v99, v99, v130
    v_fmac_f32 v98, v186, v131
    v_fmac_f32 v99, v187, v131
    v_lshlrev_b32 v184, 16, v170
    v_and_b32 v185, 0xffff0000, v170
    v_mul_f32 v100, v100, v130
    v_mul_f32 v101, v101, v130
    v_fmac_f32 v100, v184, v131
    v_fmac_f32 v101, v185, v131
    v_lshlrev_b32 v186, 16, v171
    v_and_b32 v187, 0xffff0000, v171
    v_mul_f32 v102, v102, v130
    v_mul_f32 v103, v103, v130
    v_fmac_f32 v102, v186, v131
    v_fmac_f32 v103, v187, v131
    v_lshlrev_b32 v184, 16, v172
    v_and_b32 v185, 0xffff0000, v172
    v_mul_f32 v104, v104, v130
    v_mul_f32 v105, v105, v130
    v_fmac_f32 v104, v184, v131
    v_fmac_f32 v105, v185, v131
    v_lshlrev_b32 v186, 16, v173
    v_and_b32 v187, 0xffff0000, v173
    v_mul_f32 v106, v106, v130
    v_mul_f32 v107, v107, v130
    v_fmac_f32 v106, v186, v131
    v_fmac_f32 v107, v187, v131
    v_lshlrev_b32 v184, 16, v174
    v_and_b32 v185, 0xffff0000, v174
    v_mul_f32 v108, v108, v130
    v_mul_f32 v109, v109, v130
    v_fmac_f32 v108, v184, v131
    v_fmac_f32 v109, v185, v131
    v_lshlrev_b32 v186, 16, v175
    v_and_b32 v187, 0xffff0000, v175
    v_mul_f32 v110, v110, v130
    v_mul_f32 v111, v111, v130
    v_fmac_f32 v110, v186, v131
    v_fmac_f32 v111, v187, v131
    v_lshlrev_b32 v184, 16, v176
    v_and_b32 v185, 0xffff0000, v176
    v_mul_f32 v112, v112, v130
    v_mul_f32 v113, v113, v130
    v_fmac_f32 v112, v184, v131
    v_fmac_f32 v113, v185, v131
    v_lshlrev_b32 v186, 16, v177
    v_and_b32 v187, 0xffff0000, v177
    v_mul_f32 v114, v114, v130
    v_mul_f32 v115, v115, v130
    v_fmac_f32 v114, v186, v131
    v_fmac_f32 v115, v187, v131
    v_lshlrev_b32 v184, 16, v178
    v_and_b32 v185, 0xffff0000, v178
    v_mul_f32 v116, v116, v130
    v_mul_f32 v117, v117, v130
    v_fmac_f32 v116, v184, v131
    v_fmac_f32 v117, v185, v131
    v_lshlrev_b32 v186, 16, v179
    v_and_b32 v187, 0xffff0000, v179
    v_mul_f32 v118, v118, v130
    v_mul_f32 v119, v119, v130
    v_fmac_f32 v118, v186, v131
    v_fmac_f32 v119, v187, v131
    v_lshlrev_b32 v184, 16, v180
    v_and_b32 v185, 0xffff0000, v180
    v_mul_f32 v120, v120, v130
    v_mul_f32 v121, v121, v130
    v_fmac_f32 v120, v184, v131
    v_fmac_f32 v121, v185, v131
    v_lshlrev_b32 v186, 16, v181
    v_and_b32 v187, 0xffff0000, v181
    v_mul_f32 v122, v122, v130
    v_mul_f32 v123, v123, v130
    v_fmac_f32 v122, v186, v131
    v_fmac_f32 v123, v187, v131
    v_lshlrev_b32 v184, 16, v182
    v_and_b32 v185, 0xffff0000, v182
    v_mul_f32 v124, v124, v130
    v_mul_f32 v125, v125, v130
    v_fmac_f32 v124, v184, v131
    v_fmac_f32 v125, v185, v131
    v_lshlrev_b32 v186, 16, v183
    v_and_b32 v187, 0xffff0000, v183
    v_mul_f32 v126, v126, v130
    v_mul_f32 v127, v127, v130
    v_fmac_f32 v126, v186, v131
    v_fmac_f32 v127, v187, v131
L_ms_next:
    s_cmp_lg_u64 s[94:95], 0
    s_cbranch_scc1 L_nb0_73
    s_cmp_lg_u64 s[96:97], 0
    s_cbranch_scc1 L_nb1_74
    s_cmp_lg_u64 s[98:99], 0
    s_cbranch_scc1 L_nb2_75
    s_cmp_lg_u64 s[100:101], 0
    s_cbranch_scc1 L_nb3_76
    s_branch L_ms_done
L_nb0_73:
    s_ff1_i32_b64 s89, s[94:95]
    s_bitset0_b64 s[94:95], s89
    s_add_u32 s89, s89, 0
    s_branch L_nb_done_72
L_nb1_74:
    s_ff1_i32_b64 s89, s[96:97]
    s_bitset0_b64 s[96:97], s89
    s_add_u32 s89, s89, 64
    s_branch L_nb_done_72
L_nb2_75:
    s_ff1_i32_b64 s89, s[98:99]
    s_bitset0_b64 s[98:99], s89
    s_add_u32 s89, s89, 128
    s_branch L_nb_done_72
L_nb3_76:
    s_ff1_i32_b64 s89, s[100:101]
    s_bitset0_b64 s[100:101], s89
    s_add_u32 s89, s89, 192
L_nb_done_72:
    s_and_b32 s87, s22, 3
    s_add_u32 s22, s22, 1
    s_cmp_lg_u32 s87, s52
    s_cbranch_scc1 L_ms_next
    s_add_u32 s88, s55, s89
    s_mul_i32 s88, s88, 8448
    s_add_u32 s87, s52, 0
    s_and_b32 s87, s87, 3
    s_lshl_b32 s87, s87, 11
    s_add_u32 s87, s87, s88
    buffer_load_dwordx4 a[64:67], v60, s[32:35], s87 offen sc1
    buffer_load_dwordx4 a[68:71], v60, s[32:35], s87 offen offset:1024 sc1
    s_add_u32 s87, s52, 1
    s_and_b32 s87, s87, 3
    s_lshl_b32 s87, s87, 11
    s_add_u32 s87, s87, s88
    buffer_load_dwordx4 a[72:75], v60, s[32:35], s87 offen sc1
    buffer_load_dwordx4 a[76:79], v60, s[32:35], s87 offen offset:1024 sc1
    s_add_u32 s87, s52, 2
    s_and_b32 s87, s87, 3
    s_lshl_b32 s87, s87, 11
    s_add_u32 s87, s87, s88
    buffer_load_dwordx4 a[80:83], v60, s[32:35], s87 offen sc1
    buffer_load_dwordx4 a[84:87], v60, s[32:35], s87 offen offset:1024 sc1
    s_add_u32 s87, s52, 3
    s_and_b32 s87, s87, 3
    s_lshl_b32 s87, s87, 11
    s_add_u32 s87, s87, s88
    buffer_load_dwordx4 a[88:91], v60, s[32:35], s87 offen sc1
    buffer_load_dwordx4 a[92:95], v60, s[32:35], s87 offen offset:1024 sc1
    s_add_u32 s88, s88, 8192
    buffer_load_dword a128, v249, s[32:35], s88 offen sc1
    buffer_load_dword a129, v249, s[32:35], s88 offen offset:128 sc1
    s_mov_b32 s83, 6
    s_mov_b32 s82, 2
    s_cmp_eq_u32 s93, 0
    s_cbranch_scc1 L_hk_ret
    s_mov_b32 s82, 0
    s_waitcnt vmcnt(0)
    s_branch L_ms_fold
L_ms_done:
    s_mov_b32 s23, 2
    s_branch L_hk_return
L_adv_slow:
    s_sub_u32 s89, s60, s61
    s_cmp_eq_u32 s65, 0
    s_cbranch_scc1 L_adv_h
    s_cmp_eq_u32 s65, 2
    s_cbranch_scc1 L_adv_skip
    s_mov_b32 s65, 2
    s_mov_b32 s53, 3584
    s_mov_b32 s79, 3584
    s_mov_b32 s68, 0x4000
    s_mov_b32 s69, 0x4000
    s_mov_b32 s66, 0
    s_mov_b32 s61, 0
    s_cmp_lg_u32 s52, 0
    s_cbranch_scc1 L_adv_skip
    s_cmp_eq_u32 s67, 0
    s_cbranch_scc1 L_adv_skip
    s_cmp_lg_u32 s23, 0
    s_cbranch_scc1 L_adv_skip
    buffer_load_dword v61, v62, s[28:31], 0 offen sc0 sc1
    s_branch L_adv_skip
L_adv_h:
    s_cmp_lg_u64 s[36:37], 0
    s_cbranch_scc1 L_nb0_78
    s_cmp_lg_u64 s[38:39], 0
    s_cbranch_scc1 L_nb1_79
    s_cmp_lg_u64 s[40:41], 0
    s_cbranch_scc1 L_nb2_80
    s_cmp_lg_u64 s[42:43], 0
    s_cbranch_scc1 L_nb3_81
    s_branch L_adv_none
L_nb0_78:
    s_ff1_i32_b64 s87, s[36:37]
    s_bitset0_b64 s[36:37], s87
    v_readlane_b32 s88, v52, s87
    s_add_u32 s87, s87, 0
    s_branch L_nb_done_77
L_nb1_79:
    s_ff1_i32_b64 s87, s[38:39]
    s_bitset0_b64 s[38:39], s87
    v_readlane_b32 s88, v53, s87
    s_add_u32 s87, s87, 64
    s_branch L_nb_done_77
L_nb2_80:
    s_ff1_i32_b64 s87, s[40:41]
    s_bitset0_b64 s[40:41], s87
    v_readlane_b32 s88, v54, s87
    s_add_u32 s87, s87, 128
    s_branch L_nb_done_77
L_nb3_81:
    s_ff1_i32_b64 s87, s[42:43]
    s_bitset0_b64 s[42:43], s87
    v_readlane_b32 s88, v55, s87
    s_add_u32 s87, s87, 192
L_nb_done_77:
    s_and_b32 s60, s88, 255
    s_add_u32 s60, s60, s89
    s_lshr_b32 s61, s88, 8
    s_mov_b32 s66, 1
    s_branch L_adv_set
L_adv_none:
    s_mov_b32 s65, 1
    s_add_u32 s60, s89, 8
    s_mov_b32 s61, s57
    s_mov_b32 s66, s59
    s_mov_b32 s87, s55
L_adv_set:
    s_and_b32 s88, s87, 15
    s_lshr_b32 s87, s87, 4
    s_lshl_b32 s62, s87, 8
    s_lshl_b32 s63, s88, 10
    v_readlane_b32 s0, v57, s88
    s_cmp_eq_u32 s0, 0
    s_cselect_b32 s0, 0x100000, s0
    s_lshl_b32 s64, s88, 17
    s_lshl_b32 s87, s87, 13
    s_add_u32 s64, s64, s87
    s_cmp_eq_u32 s65, 1
    s_cbranch_scc1 L_adv_claim
    s_cmp_lt_u32 s60, s61
    s_cbranch_scc1 L_adv_done
    s_branch L_adv_slow
L_adv_claim:
    v_mov_b32 v26, 1
    s_mov_b64 exec, 1
    ds_add_rtn_u32 v27, v63, v26 offset:40
    s_mov_b64 exec, -1
    s_waitcnt lgkmcnt(0)
    v_readfirstlane_b32 s60, v27
    s_cmp_lt_u32 s60, s61
    s_cbranch_scc0 L_adv_slow
    s_mov_b32 s1, s60
    s_branch L_adv_done
L_qcopy:
    s_mov_b32 s78, 0
    s_bitcmp1_b32 s80, 14
    s_cbranch_scc1 L_qcopy1
    v_accvgpr_read_b32 v216, a0
    v_accvgpr_read_b32 v217, a1
    v_accvgpr_read_b32 v218, a2
    v_accvgpr_read_b32 v219, a3
    v_accvgpr_read_b32 v220, a4
    v_accvgpr_read_b32 v221, a5
    v_accvgpr_read_b32 v222, a6
    v_accvgpr_read_b32 v223, a7
    v_accvgpr_read_b32 v224, a8
    v_accvgpr_read_b32 v225, a9
    v_accvgpr_read_b32 v226, a10
    v_accvgpr_read_b32 v227, a11
    v_accvgpr_read_b32 v228, a12
    v_accvgpr_read_b32 v229, a13
    v_accvgpr_read_b32 v230, a14
    v_accvgpr_read_b32 v231, a15
    v_accvgpr_read_b32 v232, a16
    v_accvgpr_read_b32 v233, a17
    v_accvgpr_read_b32 v234, a18
    v_accvgpr_read_b32 v235, a19
    v_accvgpr_read_b32 v236, a20
    v_accvgpr_read_b32 v237, a21
    v_accvgpr_read_b32 v238, a22
    v_accvgpr_read_b32 v239, a23
    v_accvgpr_read_b32 v240, a24
    v_accvgpr_read_b32 v241, a25
    v_accvgpr_read_b32 v242, a26
    v_accvgpr_read_b32 v243, a27
    v_accvgpr_read_b32 v244, a28
    v_accvgpr_read_b32 v245, a29
    v_accvgpr_read_b32 v246, a30
    v_accvgpr_read_b32 v247, a31
    s_branch L_qcopy_ret
L_qcopy1:
    v_accvgpr_read_b32 v216, a32
    v_accvgpr_read_b32 v217, a33
    v_accvgpr_read_b32 v218, a34
    v_accvgpr_read_b32 v219, a35
    v_accvgpr_read_b32 v220, a36
    v_accvgpr_read_b32 v221, a37
    v_accvgpr_read_b32 v222, a38
    v_accvgpr_read_b32 v223, a39
    v_accvgpr_read_b32 v224, a40
    v_accvgpr_read_b32 v225, a41
    v_accvgpr_read_b32 v226, a42
    v_accvgpr_read_b32 v227, a43
    v_accvgpr_read_b32 v228, a44
    v_accvgpr_read_b32 v229, a45
    v_accvgpr_read_b32 v230, a46
    v_accvgpr_read_b32 v231, a47
    v_accvgpr_read_b32 v232, a48
    v_accvgpr_read_b32 v233, a49
    v_accvgpr_read_b32 v234, a50
    v_accvgpr_read_b32 v235, a51
    v_accvgpr_read_b32 v236, a52
    v_accvgpr_read_b32 v237, a53
    v_accvgpr_read_b32 v238, a54
    v_accvgpr_read_b32 v239, a55
    v_accvgpr_read_b32 v240, a56
    v_accvgpr_read_b32 v241, a57
    v_accvgpr_read_b32 v242, a58
    v_accvgpr_read_b32 v243, a59
    v_accvgpr_read_b32 v244, a60
    v_accvgpr_read_b32 v245, a61
    v_accvgpr_read_b32 v246, a62
    v_accvgpr_read_b32 v247, a63
    s_branch L_qcopy_ret
L_qstage:
    s_mov_b32 s66, 0
    s_bitcmp1_b32 s80, 14
    s_cbranch_scc1 L_qstage1
    buffer_load_dwordx4 a[0:3], v22, s[12:15], s64 offen
    buffer_load_dwordx4 a[4:7], v22, s[12:15], s64 offen offset:32
    buffer_load_dwordx4 a[8:11], v22, s[12:15], s64 offen offset:64
    buffer_load_dwordx4 a[12:15], v22, s[12:15], s64 offen offset:96
    buffer_load_dwordx4 a[16:19], v22, s[12:15], s64 offen offset:128
    buffer_load_dwordx4 a[20:23], v22, s[12:15], s64 offen offset:160
    buffer_load_dwordx4 a[24:27], v22, s[12:15], s64 offen offset:192
    buffer_load_dwordx4 a[28:31], v22, s[12:15], s64 offen offset:224
    s_branch L_qstage_ret
L_qstage1:
    buffer_load_dwordx4 a[32:35], v22, s[12:15], s64 offen
    buffer_load_dwordx4 a[36:39], v22, s[12:15], s64 offen offset:32
    buffer_load_dwordx4 a[40:43], v22, s[12:15], s64 offen offset:64
    buffer_load_dwordx4 a[44:47], v22, s[12:15], s64 offen offset:96
    buffer_load_dwordx4 a[48:51], v22, s[12:15], s64 offen offset:128
    buffer_load_dwordx4 a[52:55], v22, s[12:15], s64 offen offset:160
    buffer_load_dwordx4 a[56:59], v22, s[12:15], s64 offen offset:192
    buffer_load_dwordx4 a[60:63], v22, s[12:15], s64 offen offset:224
    s_branch L_qstage_ret
L_mask:
    v_mov_b32 v26, 0xd0000000
    s_sub_i32 s88, s87, 0
    v_cmp_gt_i32 vcc, s88, v58
    s_nop 1
    v_cndmask_b32 v128, v26, v128, vcc
    s_sub_i32 s88, s87, 1
    v_cmp_gt_i32 vcc, s88, v58
    s_nop 1
    v_cndmask_b32 v129, v26, v129, vcc
    s_sub_i32 s88, s87, 2
    v_cmp_gt_i32 vcc, s88, v58
    s_nop 1
    v_cndmask_b32 v130, v26, v130, vcc
    s_sub_i32 s88, s87, 3
    v_cmp_gt_i32 vcc, s88, v58
    s_nop 1
    v_cndmask_b32 v131, v26, v131, vcc
    s_sub_i32 s88, s87, 8
    v_cmp_gt_i32 vcc, s88, v58
    s_nop 1
    v_cndmask_b32 v132, v26, v132, vcc
    s_sub_i32 s88, s87, 9
    v_cmp_gt_i32 vcc, s88, v58
    s_nop 1
    v_cndmask_b32 v133, v26, v133, vcc
    s_sub_i32 s88, s87, 10
    v_cmp_gt_i32 vcc, s88, v58
    s_nop 1
    v_cndmask_b32 v134, v26, v134, vcc
    s_sub_i32 s88, s87, 11
    v_cmp_gt_i32 vcc, s88, v58
    s_nop 1
    v_cndmask_b32 v135, v26, v135, vcc
    s_sub_i32 s88, s87, 16
    v_cmp_gt_i32 vcc, s88, v58
    s_nop 1
    v_cndmask_b32 v136, v26, v136, vcc
    s_sub_i32 s88, s87, 17
    v_cmp_gt_i32 vcc, s88, v58
    s_nop 1
    v_cndmask_b32 v137, v26, v137, vcc
    s_sub_i32 s88, s87, 18
    v_cmp_gt_i32 vcc, s88, v58
    s_nop 1
    v_cndmask_b32 v138, v26, v138, vcc
    s_sub_i32 s88, s87, 19
    v_cmp_gt_i32 vcc, s88, v58
    s_nop 1
    v_cndmask_b32 v139, v26, v139, vcc
    s_sub_i32 s88, s87, 24
    v_cmp_gt_i32 vcc, s88, v58
    s_nop 1
    v_cndmask_b32 v140, v26, v140, vcc
    s_sub_i32 s88, s87, 25
    v_cmp_gt_i32 vcc, s88, v58
    s_nop 1
    v_cndmask_b32 v141, v26, v141, vcc
    s_sub_i32 s88, s87, 26
    v_cmp_gt_i32 vcc, s88, v58
    s_nop 1
    v_cndmask_b32 v142, v26, v142, vcc
    s_sub_i32 s88, s87, 27
    v_cmp_gt_i32 vcc, s88, v58
    s_nop 1
    v_cndmask_b32 v143, v26, v143, vcc
    s_branch L_mask_ret
.section .rodata,"a"
.p2align 6
.amdhsa_kernel standalone__paged_block_table_kv_pagedattention__sampling_kernel
  .amdhsa_next_free_vgpr 432
  .amdhsa_next_free_sgpr 102
  .amdhsa_accum_offset 256
  .amdhsa_group_segment_fixed_size 0
  .amdhsa_kernarg_size 64
  .amdhsa_user_sgpr_count 2
  .amdhsa_user_sgpr_kernarg_segment_ptr 1
  .amdhsa_system_sgpr_workgroup_id_x 1
.end_amdhsa_kernel
```
